```python
import torch

def _softmax(x, axis=-1):
    return torch.softmax(x, dim=axis)
def _gelu(x):
    return torch.nn.functional.gelu(x, approximate="tanh")
def _silu(x):
    return torch.nn.functional.silu(x)
def _sigmoid(x):
    return torch.sigmoid(x)
def _layernorm(x, axis=-1, eps=1e-5):
    m = x.mean(dim=axis, keepdim=True)
    v = x.var(dim=axis, keepdim=True, unbiased=False)
    return (x - m) / torch.sqrt(v + eps)
def _scatter_add(tgt, idx, src, axis=0):
    return tgt.clone().index_add_(axis, idx, src)
def _segment_sum(src, seg, n):
    out = torch.zeros((n,) + src.shape[1:], dtype=src.dtype)
    return out.index_add_(0, seg, src)
def _pad(x, pw):
    flat = tuple(v for pair in reversed(pw) for v in pair)
    return torch.nn.functional.pad(x, flat)

kernel_name = 'recurrent_scan__ssm_conv_h3__geglu_ffn__prompt'

def setup_inputs():

    _w = (lambda a: (lambda t: t.to(torch.bfloat16) if t.is_floating_point() else t)(torch.as_tensor(a)))
    def _A_setup():
        B, S, D = 1, 2048, 448
        ks = 4
        return {
            "q": _w((lambda *s: torch.randn(*s, dtype=torch.bfloat16) * 0.05)(B, S, D)),
            "k": _w((lambda *s: torch.randn(*s, dtype=torch.bfloat16) * 0.2)(B, S, D)),
            "v": _w((lambda *s: torch.randn(*s, dtype=torch.bfloat16) * 0.2)(B, S, D)),
            "shift_k": _w((lambda *s: torch.randn(*s, dtype=torch.bfloat16) * 0.2)(D, ks) * 0.5),
            "ssm_k": _w((lambda *s: torch.randn(*s, dtype=torch.bfloat16) * 0.2)(D, S) * (1.0 / S ** 0.5)),
            "ssm_D": _w((lambda *s: torch.randn(*s, dtype=torch.bfloat16) * 0.2)(D)),
        }
    _A_in = _A_setup()

    def _B_setup():
        B, S, D, F = 1, 2048, 448, 1792
        return {
            "x": _w((lambda *s: torch.randn(*s, dtype=torch.bfloat16) * 0.05)(B, S, D)),
            "w_gate": _w((lambda *s: torch.randn(*s, dtype=torch.bfloat16) * 0.1)(D, F)),
            "w_up": _w((lambda *s: torch.randn(*s, dtype=torch.bfloat16) * 0.1)(D, F)),
            "w_down": _w((lambda *s: torch.randn(*s, dtype=torch.bfloat16) * 0.1)(F, D)),
        }
    _B_in = _B_setup()

    return {
        "A_q": _A_in["q"],
        "A_k": _A_in["k"],
        "A_v": _A_in["v"],
        "A_shift_k": _A_in["shift_k"],
        "A_ssm_k": _A_in["ssm_k"],
        "A_ssm_D": _A_in["ssm_D"],
        "B_x": _B_in["x"],
        "B_w_gate": _B_in["w_gate"],
        "B_w_up": _B_in["w_up"],
        "B_w_down": _B_in["w_down"],
    }

def reference(A_q, A_k, A_v, A_shift_k, A_ssm_k, A_ssm_D, B_x, B_w_gate, B_w_up, B_w_down):
    def _A_ref(q, k, v, shift_k, ssm_k, ssm_D):
        B, S, D = q.shape
        ks = shift_k.shape[-1]
        k_pad = _pad(k, ((0, 0), (ks - 1, 0), (0, 0)))
        k_shift = torch.zeros_like(k)
        for t in range(ks):
            k_shift = k_shift + k_pad[:, t:t + S, :] * shift_k[:, ks - 1 - t][None, None, :]
        kv = k_shift * v
        L = 2 * S
        kv_pad = _pad(kv, ((0, 0), (0, S), (0, 0)))
        kf_pad = _pad(ssm_k, ((0, 0), (0, S)))
        kv_f = (lambda x, axes=(-2,-1): torch.fft.rfft2(x.float(), dim=axes))(kv_pad[:, None, :, :], axes=(1, 2))
        kf_f = (lambda x, axes=(-2,-1): torch.fft.rfft2(x.float(), dim=axes))(kf_pad[:, None, :], axes=(1, 2))
        kf_f = (lambda x, *d: x.permute(*d))(kf_f, 1, 2, 0)
        y_f = kv_f * kf_f[None, :, :, :]
        y = (lambda x, s, axes=(-2,-1): torch.fft.irfft2(x, s=s, dim=axes).to(torch.bfloat16))(y_f, (1, L), axes=(1, 2))[:, 0, :S, :]
        y = y + kv * ssm_D[None, None, :]
        return q * y

    def _B_ref(x, w_gate, w_up, w_down):
        return (_gelu(x @ w_gate) * (x @ w_up)) @ w_down

    x = A_q
    xn = _layernorm(x, axis=-1)
    s = _A_ref(xn, A_k, A_v, A_shift_k, A_ssm_k, A_ssm_D)
    g = _silu(_B_ref(xn, B_w_gate, B_w_up, B_w_down))
    return x + s * g
```

```asm
; @launch grid=(256,1,1) block=(256,1,1) lds=163840
.amdgcn_target "amdgcn-amd-amdhsa--gfx950"
.text
.globl recurrent_scan__ssm_conv_h3__geglu_ffn__prompt_kernel
.p2align 8
.type recurrent_scan__ssm_conv_h3__geglu_ffn__prompt_kernel,@function
recurrent_scan__ssm_conv_h3__geglu_ffn__prompt_kernel:
s_getpc_b64 s[12:13]
L_code_pc:
s_load_dwordx16 s[16:31], s[0:1], 0
s_load_dwordx8 s[32:39], s[0:1], 64
s_load_dwordx2 s[40:41], s[0:1], 96
v_lshrrev_b32 v1, 6, v0
v_and_b32 v0, 63, v0
s_cmp_ge_u32 s2, 256
v_readfirstlane_b32 s80, v1
s_cbranch_scc1 L_exit
s_lshr_b32 s14, s2, 3
s_lshl_b32 s14, s14, 2
s_add_u32 s14, s14, s80
s_mul_i32 s14, s14, 384
v_lshlrev_b32 v2, 7, v0
v_add_u32 v2, s14, v2
v_min_u32 v2, L_code_end-L_code_pc-4, v2
s_mov_b64 exec, 7
global_load_dword a250, v2, s[12:13]
s_mov_b64 exec, -1
s_and_b32 s86, s2, 7
s_lshr_b32 s85, s2, 3
s_cmp_ge_u32 s85, 28
s_cbranch_scc1 L_pre
s_mul_i32 s4, s85, 37
s_lshr_b32 s4, s4, 8
s_mul_i32 s5, s4, 7
s_sub_u32 s91, s85, s5
s_lshr_b32 s6, s86, 1
s_lshl_b32 s6, s6, 2
s_add_u32 s81, s6, s4
s_lshl_b32 s90, s86, 2
s_add_u32 s90, s90, s4
v_lshlrev_b32 v1, 4, v0
s_lshl_b32 s96, s81, 2
s_add_u32 s96, s96, s80
s_mul_i32 s96, s96, 28672
s_mul_i32 s97, s80, 29184
s_add_u32 s97, s97, 34048
s_mul_i32 s98, s91, 9
s_lshr_b32 s98, s98, 2
v_lshrrev_b32 v242, 5, v0
v_mul_u32_u24 v240, 896, v242
v_lshlrev_b32 v242, 3, v242
v_and_b32 v243, 31, v0
v_xor_b32 v243, v243, v242
v_lshl_add_u32 v240, v243, 4, v240
s_waitcnt lgkmcnt(0)
s_mov_b32 s44, s16
s_and_b32 s45, s17, 0xffff
s_mov_b32 s46, 1835008
s_mov_b32 s47, 0x20000
s_add_u32 s99, s97, 16640
s_mov_b32 s4, 16
Lxd_1:
s_mul_i32 s5, s98, 1040
s_mul_i32 s6, s98, 1792
s_add_u32 m0, s5, s97
s_add_u32 s6, s6, s96
s_add_u32 s98, s98, 1
buffer_load_dwordx4 v240, s[44:47], s6 offen lds
s_and_b32 s98, s98, 15
s_sub_u32 s4, s4, 1
s_cmp_lg_u32 s4, 0
s_cbranch_scc1 Lxd_1
v_cmp_le_u32 vcc, 24, v0
v_mov_b32 v242, 512
v_lshlrev_b32 v241, 4, v0
v_cndmask_b32 v242, 0, v242, vcc
v_add_u32 v241, v241, v242
s_and_b32 s4, s86, 1
s_mul_i32 s82, s4, 7
s_add_u32 s82, s82, s91
v_lshrrev_b32 v6, 4, v0
v_lshlrev_b32 v6, 6, v6
v_bfe_u32 v7, v0, 1, 3
v_add_u32 v6, v6, v7
v_mul_u32_u24 v6, 3584, v6
v_and_b32 v7, 1, v0
v_lshl_add_u32 v5, v7, 7, v6
s_and_b32 s4, s81, 3
s_lshl_b32 s4, s4, 1
s_lshr_b32 s75, s80, 1
s_add_u32 s4, s4, s75
s_mul_i32 s4, s4, 28672
s_lshl_b32 s75, s82, 8
s_add_u32 s75, s75, s4
s_bitcmp1_b32 s80, 0
s_cselect_b32 s48, s32, s30
s_cselect_b32 s49, s33, s31
s_and_b32 s49, s49, 0xffff
s_mov_b32 s50, 1605632
s_mov_b32 s51, 0x20000
s_add_u32 s96, s96, 512
s_mov_b32 exec_hi, 0xffff
s_mul_i32 s5, s98, 784
s_mul_i32 s6, s98, 1792
s_add_u32 m0, s5, s99
s_add_u32 s6, s6, s96
s_add_u32 s98, s98, 1
buffer_load_dwordx4 v241, s[44:47], s6 offen lds
s_and_b32 s98, s98, 15
s_mul_i32 s5, s98, 784
s_mul_i32 s6, s98, 1792
s_add_u32 m0, s5, s99
s_add_u32 s6, s6, s96
s_add_u32 s98, s98, 1
buffer_load_dwordx4 v241, s[44:47], s6 offen lds
s_and_b32 s98, s98, 15
s_mul_i32 s5, s98, 784
s_mul_i32 s6, s98, 1792
s_add_u32 m0, s5, s99
s_add_u32 s6, s6, s96
s_add_u32 s98, s98, 1
buffer_load_dwordx4 v241, s[44:47], s6 offen lds
s_and_b32 s98, s98, 15
s_mul_i32 s5, s98, 784
s_mul_i32 s6, s98, 1792
s_add_u32 m0, s5, s99
s_add_u32 s6, s6, s96
s_add_u32 s98, s98, 1
buffer_load_dwordx4 v241, s[44:47], s6 offen lds
s_and_b32 s98, s98, 15
s_mul_i32 s5, s98, 784
s_mul_i32 s6, s98, 1792
s_add_u32 m0, s5, s99
s_add_u32 s6, s6, s96
s_add_u32 s98, s98, 1
buffer_load_dwordx4 v241, s[44:47], s6 offen lds
s_and_b32 s98, s98, 15
s_mul_i32 s5, s98, 784
s_mul_i32 s6, s98, 1792
s_add_u32 m0, s5, s99
s_add_u32 s6, s6, s96
s_add_u32 s98, s98, 1
buffer_load_dwordx4 v241, s[44:47], s6 offen lds
s_and_b32 s98, s98, 15
s_mul_i32 s5, s98, 784
s_mul_i32 s6, s98, 1792
s_add_u32 m0, s5, s99
s_add_u32 s6, s6, s96
s_add_u32 s98, s98, 1
buffer_load_dwordx4 v241, s[44:47], s6 offen lds
s_and_b32 s98, s98, 15
s_mul_i32 s5, s98, 784
s_mul_i32 s6, s98, 1792
s_add_u32 m0, s5, s99
s_add_u32 s6, s6, s96
s_add_u32 s98, s98, 1
buffer_load_dwordx4 v241, s[44:47], s6 offen lds
s_and_b32 s98, s98, 15
s_mov_b32 exec_hi, -1
v_lshrrev_b32 v10, 4, v0
v_mul_u32_u24 v2, 57344, v10
v_and_b32 v11, 15, v0
v_lshl_add_u32 v2, v11, 4, v2
s_lshr_b32 s4, s80, 1
s_lshl_b32 s4, s4, 3
s_mul_i32 s83, s4, 3584
s_lshl_b32 s5, s82, 8
s_add_u32 s83, s83, s5
s_mul_i32 s84, s4, 1056
s_and_b32 s5, s80, 1
s_mul_i32 s5, s5, 17024
s_add_u32 s84, s84, s5
s_mul_i32 s89, s86, 28
s_add_u32 s89, s89, s85
s_mov_b32 s52, s40
s_and_b32 s53, s41, 0xffff
s_mov_b32 s54, 11030528
s_mov_b32 s55, 0x20000
s_mov_b32 s56, s34
s_and_b32 s57, s35, 0xffff
s_mov_b32 s58, 1605632
s_mov_b32 s59, 0x20000
s_mov_b32 s60, s24
s_and_b32 s61, s25, 0xffff
s_mov_b32 s62, 1835008
s_mov_b32 s63, 0x20000
s_mov_b32 s64, s36
s_and_b32 s65, s37, 0xffff
s_mov_b32 s66, 1835008
s_mov_b32 s67, 0x20000
s_mov_b32 s68, s26
s_and_b32 s69, s27, 0xffff
s_mov_b32 s70, 896
s_mov_b32 s71, 0x20000
v_and_b32 v11, 1, v10
v_mul_u32_u24 v3, 17024, v11
v_lshrrev_b32 v11, 5, v0
v_lshlrev_b32 v12, 3, v11
v_bfe_u32 v13, v0, 2, 2
v_add_u32 v12, v12, v13
v_mul_u32_u24 v12, 1056, v12
v_add_u32 v3, v3, v12
v_and_b32 v13, 3, v0
v_lshl_add_u32 v3, v13, 3, v3
v_add_u32 v14, 68096, v3
v_and_b32 v13, 31, v0
v_lshrrev_b32 v12, 1, v13
v_and_b32_e64 v13, 1, v13
v_mul_u32_u24 v242, 1040, v12
v_lshl_add_u32 v242, v11, 4, v242
v_lshl_add_u32 v242, v13, 9, v242
v_add_u32 v242, s97, v242
v_lshlrev_b32 v15, 7, v13
v_sub_u32 v243, v242, v15
v_add_u32 v242, v242, v15
v_mul_u32_u24 v244, 784, v12
v_lshl_add_u32 v244, v11, 4, v244
v_mul_u32_u24 v13, 384, v13
v_add_u32 v244, v244, v13
v_add_u32 v244, s99, v244
s_mov_b32 s87, 0x3f803f80
s_mov_b32 s88, 0xffff0000
v_mov_b32 v6, 0
v_mov_b32 v7, 0
v_mov_b32 v8, 0
v_mov_b32 v9, 0
v_mov_b32 v10, 0
v_mov_b32 v11, 0
v_mov_b32 v12, 0
v_mov_b32_e64 v13, 0
s_waitcnt vmcnt(8)
ds_read_b128 v[16:19], v242 offset:0
ds_read_b128 v[20:23], v242 offset:32
ds_read_b128 v[24:27], v242 offset:64
ds_read_b128 v[28:31], v242 offset:96
ds_read_b128 v[32:35], v243 offset:128
ds_read_b128 v[36:39], v243 offset:160
ds_read_b128 v[40:43], v243 offset:192
ds_read_b128 v[44:47], v243 offset:224
ds_read_b128 v[48:51], v242 offset:256
ds_read_b128 v[52:55], v242 offset:288
ds_read_b128 v[56:59], v242 offset:320
ds_read_b128 v[60:63], v242 offset:352
ds_read_b128 v[64:67], v243 offset:384
ds_read_b128 v[68:71], v243 offset:416
ds_read_b128 v[72:75], v243 offset:448
ds_read_b128 v[76:79], v243 offset:480
s_waitcnt lgkmcnt(14)
s_nop 0
v_dot2_f32_bf16 v6, v16, s87, v6
v_dot2_f32_bf16 v10, v16, v16, v10
v_dot2_f32_bf16 v7, v17, s87, v7
v_dot2_f32_bf16 v11, v17, v17, v11
v_dot2_f32_bf16 v8, v18, s87, v8
v_dot2_f32_bf16 v12, v18, v18, v12
v_dot2_f32_bf16 v9, v19, s87, v9
v_dot2_f32_bf16 v13, v19, v19, v13
s_mov_b32 exec_hi, 0xffff
s_mul_i32 s5, s98, 784
s_mul_i32 s6, s98, 1792
s_add_u32 m0, s5, s99
s_add_u32 s6, s6, s96
s_add_u32 s98, s98, 1
buffer_load_dwordx4 v241, s[44:47], s6 offen lds
s_and_b32 s98, s98, 15
s_mov_b32 exec_hi, -1
s_waitcnt lgkmcnt(14)
v_dot2_f32_bf16 v6, v20, s87, v6
v_dot2_f32_bf16 v10, v20, v20, v10
v_dot2_f32_bf16 v7, v21, s87, v7
v_dot2_f32_bf16 v11, v21, v21, v11
v_dot2_f32_bf16 v8, v22, s87, v8
v_dot2_f32_bf16 v12, v22, v22, v12
v_dot2_f32_bf16 v9, v23, s87, v9
v_dot2_f32_bf16 v13, v23, v23, v13
s_mov_b32 exec_hi, 0xffff
s_mul_i32 s5, s98, 784
s_mul_i32 s6, s98, 1792
s_add_u32 m0, s5, s99
s_add_u32 s6, s6, s96
s_add_u32 s98, s98, 1
buffer_load_dwordx4 v241, s[44:47], s6 offen lds
s_and_b32 s98, s98, 15
s_mov_b32 exec_hi, -1
s_waitcnt lgkmcnt(13)
v_dot2_f32_bf16 v6, v24, s87, v6
v_dot2_f32_bf16 v10, v24, v24, v10
v_dot2_f32_bf16 v7, v25, s87, v7
v_dot2_f32_bf16 v11, v25, v25, v11
v_dot2_f32_bf16 v8, v26, s87, v8
v_dot2_f32_bf16 v12, v26, v26, v12
v_dot2_f32_bf16 v9, v27, s87, v9
v_dot2_f32_bf16 v13, v27, v27, v13
s_mov_b32 exec_hi, 0xffff
s_mul_i32 s5, s98, 784
s_mul_i32 s6, s98, 1792
s_add_u32 m0, s5, s99
s_add_u32 s6, s6, s96
s_add_u32 s98, s98, 1
buffer_load_dwordx4 v241, s[44:47], s6 offen lds
s_and_b32 s98, s98, 15
s_mov_b32 exec_hi, -1
s_waitcnt lgkmcnt(12)
v_dot2_f32_bf16 v6, v28, s87, v6
v_dot2_f32_bf16 v10, v28, v28, v10
v_dot2_f32_bf16 v7, v29, s87, v7
v_dot2_f32_bf16 v11, v29, v29, v11
v_dot2_f32_bf16 v8, v30, s87, v8
v_dot2_f32_bf16 v12, v30, v30, v12
v_dot2_f32_bf16 v9, v31, s87, v9
v_dot2_f32_bf16 v13, v31, v31, v13
s_mov_b32 exec_hi, 0xffff
s_mul_i32 s5, s98, 784
s_mul_i32 s6, s98, 1792
s_add_u32 m0, s5, s99
s_add_u32 s6, s6, s96
s_add_u32 s98, s98, 1
buffer_load_dwordx4 v241, s[44:47], s6 offen lds
s_and_b32 s98, s98, 15
s_mov_b32 exec_hi, -1
s_waitcnt lgkmcnt(11)
v_dot2_f32_bf16 v6, v32, s87, v6
v_dot2_f32_bf16 v10, v32, v32, v10
v_dot2_f32_bf16 v7, v33, s87, v7
v_dot2_f32_bf16 v11, v33, v33, v11
v_dot2_f32_bf16 v8, v34, s87, v8
v_dot2_f32_bf16 v12, v34, v34, v12
v_dot2_f32_bf16 v9, v35, s87, v9
v_dot2_f32_bf16 v13, v35, v35, v13
s_mov_b32 exec_hi, 0xffff
s_mul_i32 s5, s98, 784
s_mul_i32 s6, s98, 1792
s_add_u32 m0, s5, s99
s_add_u32 s6, s6, s96
s_add_u32 s98, s98, 1
buffer_load_dwordx4 v241, s[44:47], s6 offen lds
s_and_b32 s98, s98, 15
s_mov_b32 exec_hi, -1
s_waitcnt lgkmcnt(10)
v_dot2_f32_bf16 v6, v36, s87, v6
v_dot2_f32_bf16 v10, v36, v36, v10
v_dot2_f32_bf16 v7, v37, s87, v7
v_dot2_f32_bf16 v11, v37, v37, v11
v_dot2_f32_bf16 v8, v38, s87, v8
v_dot2_f32_bf16 v12, v38, v38, v12
v_dot2_f32_bf16 v9, v39, s87, v9
v_dot2_f32_bf16 v13, v39, v39, v13
s_mov_b32 exec_hi, 0xffff
s_mul_i32 s5, s98, 784
s_mul_i32 s6, s98, 1792
s_add_u32 m0, s5, s99
s_add_u32 s6, s6, s96
s_add_u32 s98, s98, 1
buffer_load_dwordx4 v241, s[44:47], s6 offen lds
s_and_b32 s98, s98, 15
s_mov_b32 exec_hi, -1
s_waitcnt lgkmcnt(9)
v_dot2_f32_bf16 v6, v40, s87, v6
v_dot2_f32_bf16 v10, v40, v40, v10
v_dot2_f32_bf16 v7, v41, s87, v7
v_dot2_f32_bf16 v11, v41, v41, v11
v_dot2_f32_bf16 v8, v42, s87, v8
v_dot2_f32_bf16 v12, v42, v42, v12
v_dot2_f32_bf16 v9, v43, s87, v9
v_dot2_f32_bf16 v13, v43, v43, v13
s_mov_b32 exec_hi, 0xffff
s_mul_i32 s5, s98, 784
s_mul_i32 s6, s98, 1792
s_add_u32 m0, s5, s99
s_add_u32 s6, s6, s96
s_add_u32 s98, s98, 1
buffer_load_dwordx4 v241, s[44:47], s6 offen lds
s_and_b32 s98, s98, 15
s_mov_b32 exec_hi, -1
s_waitcnt lgkmcnt(8)
v_dot2_f32_bf16 v6, v44, s87, v6
v_dot2_f32_bf16 v10, v44, v44, v10
v_dot2_f32_bf16 v7, v45, s87, v7
v_dot2_f32_bf16 v11, v45, v45, v11
v_dot2_f32_bf16 v8, v46, s87, v8
v_dot2_f32_bf16 v12, v46, v46, v12
v_dot2_f32_bf16 v9, v47, s87, v9
v_dot2_f32_bf16 v13, v47, v47, v13
s_mov_b32 exec_hi, 0xffff
s_mul_i32 s5, s98, 784
s_mul_i32 s6, s98, 1792
s_add_u32 m0, s5, s99
s_add_u32 s6, s6, s96
s_add_u32 s98, s98, 1
buffer_load_dwordx4 v241, s[44:47], s6 offen lds
s_and_b32 s98, s98, 15
s_mov_b32 exec_hi, -1
s_waitcnt lgkmcnt(7)
v_dot2_f32_bf16 v6, v48, s87, v6
v_dot2_f32_bf16 v10, v48, v48, v10
v_dot2_f32_bf16 v7, v49, s87, v7
v_dot2_f32_bf16 v11, v49, v49, v11
v_dot2_f32_bf16 v8, v50, s87, v8
v_dot2_f32_bf16 v12, v50, v50, v12
v_dot2_f32_bf16 v9, v51, s87, v9
v_dot2_f32_bf16 v13, v51, v51, v13
s_add_u32 m0, s84, 0
s_add_u32 s7, s83, 0
buffer_load_dwordx4 v2, s[48:51], s7 offen offset:0 lds
s_waitcnt lgkmcnt(6)
s_nop 0
v_dot2_f32_bf16 v6, v52, s87, v6
v_dot2_f32_bf16 v10, v52, v52, v10
v_dot2_f32_bf16 v7, v53, s87, v7
v_dot2_f32_bf16 v11, v53, v53, v11
v_dot2_f32_bf16 v8, v54, s87, v8
v_dot2_f32_bf16 v12, v54, v54, v12
v_dot2_f32_bf16 v9, v55, s87, v9
v_dot2_f32_bf16 v13, v55, v55, v13
s_add_u32 s7, s83, 2528
buffer_load_dwordx4 v2, s[48:51], s7 offen offset:1056 lds
s_waitcnt lgkmcnt(5)
s_nop 0
v_dot2_f32_bf16 v6, v56, s87, v6
v_dot2_f32_bf16 v10, v56, v56, v10
v_dot2_f32_bf16 v7, v57, s87, v7
v_dot2_f32_bf16 v11, v57, v57, v11
v_dot2_f32_bf16 v8, v58, s87, v8
v_dot2_f32_bf16 v12, v58, v58, v12
v_dot2_f32_bf16 v9, v59, s87, v9
v_dot2_f32_bf16 v13, v59, v59, v13
s_add_u32 s7, s83, 5056
buffer_load_dwordx4 v2, s[48:51], s7 offen offset:2112 lds
s_waitcnt lgkmcnt(4)
s_nop 0
v_dot2_f32_bf16 v6, v60, s87, v6
v_dot2_f32_bf16 v10, v60, v60, v10
v_dot2_f32_bf16 v7, v61, s87, v7
v_dot2_f32_bf16 v11, v61, v61, v11
v_dot2_f32_bf16 v8, v62, s87, v8
v_dot2_f32_bf16 v12, v62, v62, v12
v_dot2_f32_bf16 v9, v63, s87, v9
v_dot2_f32_bf16 v13, v63, v63, v13
s_add_u32 s7, s83, 7584
buffer_load_dwordx4 v2, s[48:51], s7 offen offset:3168 lds
s_waitcnt lgkmcnt(3)
s_nop 0
v_dot2_f32_bf16 v6, v64, s87, v6
v_dot2_f32_bf16 v10, v64, v64, v10
v_dot2_f32_bf16 v7, v65, s87, v7
v_dot2_f32_bf16 v11, v65, v65, v11
v_dot2_f32_bf16 v8, v66, s87, v8
v_dot2_f32_bf16 v12, v66, v66, v12
v_dot2_f32_bf16 v9, v67, s87, v9
v_dot2_f32_bf16 v13, v67, v67, v13
s_add_u32 m0, s84, 4224
s_add_u32 s7, s83, 14336
buffer_load_dwordx4 v2, s[48:51], s7 offen offset:0 lds
s_waitcnt lgkmcnt(2)
s_nop 0
v_dot2_f32_bf16 v6, v68, s87, v6
v_dot2_f32_bf16 v10, v68, v68, v10
v_dot2_f32_bf16 v7, v69, s87, v7
v_dot2_f32_bf16 v11, v69, v69, v11
v_dot2_f32_bf16 v8, v70, s87, v8
v_dot2_f32_bf16 v12, v70, v70, v12
v_dot2_f32_bf16 v9, v71, s87, v9
v_dot2_f32_bf16 v13, v71, v71, v13
s_add_u32 s7, s83, 16864
buffer_load_dwordx4 v2, s[48:51], s7 offen offset:1056 lds
s_waitcnt lgkmcnt(1)
s_nop 0
v_dot2_f32_bf16 v6, v72, s87, v6
v_dot2_f32_bf16 v10, v72, v72, v10
v_dot2_f32_bf16 v7, v73, s87, v7
v_dot2_f32_bf16 v11, v73, v73, v11
v_dot2_f32_bf16 v8, v74, s87, v8
v_dot2_f32_bf16 v12, v74, v74, v12
v_dot2_f32_bf16 v9, v75, s87, v9
v_dot2_f32_bf16 v13, v75, v75, v13
s_add_u32 s7, s83, 19392
buffer_load_dwordx4 v2, s[48:51], s7 offen offset:2112 lds
s_waitcnt lgkmcnt(0)
s_nop 0
v_dot2_f32_bf16 v6, v76, s87, v6
v_dot2_f32_bf16 v10, v76, v76, v10
v_dot2_f32_bf16 v7, v77, s87, v7
v_dot2_f32_bf16 v11, v77, v77, v11
v_dot2_f32_bf16 v8, v78, s87, v8
v_dot2_f32_bf16 v12, v78, v78, v12
v_dot2_f32_bf16 v9, v79, s87, v9
v_dot2_f32_bf16 v13, v79, v79, v13
s_add_u32 s7, s83, 21920
buffer_load_dwordx4 v2, s[48:51], s7 offen offset:3168 lds
s_waitcnt vmcnt(8)
s_nop 0
ds_read_b128 v[80:83], v244 offset:0
ds_read_b128 v[84:87], v244 offset:32
ds_read_b128 v[88:91], v244 offset:64
ds_read_b128 v[92:95], v244 offset:96
ds_read_b128 v[96:99], v244 offset:128
ds_read_b128 v[100:103], v244 offset:160
ds_read_b128 v[104:107], v244 offset:192
ds_read_b128 v[108:111], v244 offset:224
ds_read_b128 v[112:115], v244 offset:256
ds_read_b128 v[116:119], v244 offset:288
ds_read_b128 v[120:123], v244 offset:320
ds_read_b128 v[124:127], v244 offset:352
s_add_u32 s75, s75, 229376
s_waitcnt lgkmcnt(0)
v_mov_b32_e64 v15, v5
s_barrier
v_dot2_f32_bf16 v6, v80, s87, v6
v_dot2_f32_bf16 v10, v80, v80, v10
v_dot2_f32_bf16 v7, v81, s87, v7
v_dot2_f32_bf16 v11, v81, v81, v11
v_dot2_f32_bf16 v8, v82, s87, v8
v_dot2_f32_bf16 v12, v82, v82, v12
v_dot2_f32_bf16 v9, v83, s87, v9
v_dot2_f32_bf16 v13, v83, v83, v13
v_dot2_f32_bf16 v6, v84, s87, v6
v_dot2_f32_bf16 v10, v84, v84, v10
s_add_u32 m0, s84, 34048
s_add_u32 s7, s83, 229376
buffer_load_dwordx4 v2, s[48:51], s7 offen offset:0 lds
v_dot2_f32_bf16 v7, v85, s87, v7
v_dot2_f32_bf16 v11, v85, v85, v11
v_dot2_f32_bf16 v8, v86, s87, v8
v_dot2_f32_bf16 v12, v86, v86, v12
v_dot2_f32_bf16 v9, v87, s87, v9
v_dot2_f32_bf16 v13, v87, v87, v13
v_dot2_f32_bf16 v6, v88, s87, v6
v_dot2_f32_bf16 v10, v88, v88, v10
v_dot2_f32_bf16 v7, v89, s87, v7
v_dot2_f32_bf16 v11, v89, v89, v11
s_add_u32 s7, s83, 231904
buffer_load_dwordx4 v2, s[48:51], s7 offen offset:1056 lds
v_dot2_f32_bf16 v8, v90, s87, v8
v_dot2_f32_bf16 v12, v90, v90, v12
v_dot2_f32_bf16 v9, v91, s87, v9
v_dot2_f32_bf16 v13, v91, v91, v13
v_dot2_f32_bf16 v6, v92, s87, v6
v_dot2_f32_bf16 v10, v92, v92, v10
v_dot2_f32_bf16 v7, v93, s87, v7
v_dot2_f32_bf16 v11, v93, v93, v11
v_dot2_f32_bf16 v8, v94, s87, v8
v_dot2_f32_bf16 v12, v94, v94, v12
s_add_u32 s7, s83, 234432
buffer_load_dwordx4 v2, s[48:51], s7 offen offset:2112 lds
v_dot2_f32_bf16 v9, v95, s87, v9
v_dot2_f32_bf16 v13, v95, v95, v13
v_dot2_f32_bf16 v6, v96, s87, v6
v_dot2_f32_bf16 v10, v96, v96, v10
v_dot2_f32_bf16 v7, v97, s87, v7
v_dot2_f32_bf16 v11, v97, v97, v11
v_dot2_f32_bf16 v8, v98, s87, v8
v_dot2_f32_bf16 v12, v98, v98, v12
v_dot2_f32_bf16 v9, v99, s87, v9
v_dot2_f32_bf16 v13, v99, v99, v13
s_add_u32 s7, s83, 236960
buffer_load_dwordx4 v2, s[48:51], s7 offen offset:3168 lds
v_dot2_f32_bf16 v6, v100, s87, v6
v_dot2_f32_bf16 v10, v100, v100, v10
v_dot2_f32_bf16 v7, v101, s87, v7
v_dot2_f32_bf16 v11, v101, v101, v11
v_dot2_f32_bf16 v8, v102, s87, v8
v_dot2_f32_bf16 v12, v102, v102, v12
v_dot2_f32_bf16 v9, v103, s87, v9
v_dot2_f32_bf16 v13, v103, v103, v13
v_dot2_f32_bf16 v6, v104, s87, v6
v_dot2_f32_bf16 v10, v104, v104, v10
s_add_u32 m0, s84, 38272
s_add_u32 s7, s83, 243712
buffer_load_dwordx4 v2, s[48:51], s7 offen offset:0 lds
v_dot2_f32_bf16 v7, v105, s87, v7
v_dot2_f32_bf16 v11, v105, v105, v11
v_dot2_f32_bf16 v8, v106, s87, v8
v_dot2_f32_bf16 v12, v106, v106, v12
v_dot2_f32_bf16 v9, v107, s87, v9
v_dot2_f32_bf16 v13, v107, v107, v13
v_dot2_f32_bf16 v6, v108, s87, v6
v_dot2_f32_bf16 v10, v108, v108, v10
v_dot2_f32_bf16 v7, v109, s87, v7
v_dot2_f32_bf16 v11, v109, v109, v11
s_add_u32 s7, s83, 246240
buffer_load_dwordx4 v2, s[48:51], s7 offen offset:1056 lds
v_dot2_f32_bf16 v8, v110, s87, v8
v_dot2_f32_bf16 v12, v110, v110, v12
v_dot2_f32_bf16 v9, v111, s87, v9
v_dot2_f32_bf16 v13, v111, v111, v13
v_dot2_f32_bf16 v6, v112, s87, v6
v_dot2_f32_bf16 v10, v112, v112, v10
v_dot2_f32_bf16 v7, v113, s87, v7
v_dot2_f32_bf16 v11, v113, v113, v11
v_dot2_f32_bf16 v8, v114, s87, v8
v_dot2_f32_bf16 v12, v114, v114, v12
s_add_u32 s7, s83, 248768
buffer_load_dwordx4 v2, s[48:51], s7 offen offset:2112 lds
v_dot2_f32_bf16 v9, v115, s87, v9
v_dot2_f32_bf16 v13, v115, v115, v13
v_dot2_f32_bf16 v6, v116, s87, v6
v_dot2_f32_bf16 v10, v116, v116, v10
v_dot2_f32_bf16 v7, v117, s87, v7
v_dot2_f32_bf16 v11, v117, v117, v11
v_dot2_f32_bf16 v8, v118, s87, v8
v_dot2_f32_bf16 v12, v118, v118, v12
v_dot2_f32_bf16 v9, v119, s87, v9
v_dot2_f32_bf16 v13, v119, v119, v13
s_add_u32 s7, s83, 251296
buffer_load_dwordx4 v2, s[48:51], s7 offen offset:3168 lds
v_dot2_f32_bf16 v6, v120, s87, v6
v_dot2_f32_bf16 v10, v120, v120, v10
v_dot2_f32_bf16 v7, v121, s87, v7
v_dot2_f32_bf16 v11, v121, v121, v11
v_dot2_f32_bf16 v8, v122, s87, v8
v_dot2_f32_bf16 v12, v122, v122, v12
v_dot2_f32_bf16 v9, v123, s87, v9
v_dot2_f32_bf16 v13, v123, v123, v13
v_dot2_f32_bf16 v6, v124, s87, v6
v_dot2_f32_bf16 v10, v124, v124, v10
s_add_u32 s75, s75, 917504
s_mov_b32 exec_hi, 0
buffer_load_dword a250, v15, s[48:51], s75 offen
s_mov_b64 exec, -1
v_dot2_f32_bf16 v7, v125, s87, v7
v_dot2_f32_bf16 v11, v125, v125, v11
v_dot2_f32_bf16 v8, v126, s87, v8
v_dot2_f32_bf16 v12, v126, v126, v12
v_dot2_f32_bf16 v9, v127, s87, v9
v_dot2_f32_bf16 v13, v127, v127, v13
s_nop 2
v_add_f32 v6, v6, v7
v_add_f32 v8, v8, v9
v_add_f32 v10, v10, v11
v_add_f32 v12, v12, v13
v_add_f32 v6, v6, v8
v_add_f32 v10, v10, v12
v_mov_b32 v7, v6
v_mov_b32 v11, v10
s_nop 1
v_permlane32_swap_b32 v6, v7
v_permlane32_swap_b32 v10, v11
s_nop 1
v_add_f32 v6, v6, v7
v_add_f32_e64 v10, v10, v11
v_mul_f32 v6, 0x3b124925, v6
v_mul_f32 v10, 0x3b124925, v10
v_fma_f32 v10, -v6, v6, v10
v_max_f32 v10, 0, v10
v_cvt_pk_bf16_f32 v7, v6, v10
v_lshlrev_b32 v6, 16, v7
v_and_b32_e64 v10, s88, v7
v_add_f32 v10, 0x3727c5ac, v10
v_cvt_pk_bf16_f32 v10, v10, v10
v_lshlrev_b32 v10, 16, v10
v_sqrt_f32 v10, v10
s_nop 0
v_cvt_pk_bf16_f32 v10, v10, v10
v_lshlrev_b32 v10, 16, v10
v_rcp_f32 v8, v10
v_sub_f32 v4, 0, v6
v_mul_f32 v9, v4, v8
s_cmp_lg_u32 s82, 0
s_cbranch_scc1 Lnost_2
s_lshl_b32 s4, s81, 2
s_add_u32 s4, s4, s80
s_lshl_b32 s4, s4, 8
s_add_u32 s4, s4, 11010048
v_lshlrev_b32 v6, 3, v0
s_mov_b32 exec_hi, 0
buffer_store_dwordx2 v[8:9], v6, s[52:55], s4 offen sc1
s_mov_b32 exec_hi, -1
Lnost_2:
v_mul_f32 v6, 0xc0135761, v8
v_mul_f32 v7, v8, v8
v_mul_f32 v11, v10, v10
v_mul_f32 v7, v7, v8
v_accvgpr_write_b32 a144, v6
v_mul_f32 v7, 0xbdd2d3e8, v7
v_accvgpr_write_b32 a146, v11
v_accvgpr_write_b32 a145, v7
v_lshlrev_b32 v6, 16, v16
v_lshlrev_b32 v8, 16, v17
v_lshlrev_b32 v10, 16, v18
v_lshlrev_b32 v12, 16, v19
v_and_b32 v7, s88, v16
v_and_b32 v9, s88, v17
v_and_b32 v11, s88, v18
v_and_b32 v13, s88, v19
v_add_f32 v6, v6, v4
v_add_f32 v8, v8, v4
v_add_f32 v10, v10, v4
v_add_f32 v12, v12, v4
v_add_f32 v7, v7, v4
v_add_f32 v9, v9, v4
v_add_f32 v11, v11, v4
v_add_f32 v13, v13, v4
v_cvt_pk_bf16_f32 v16, v6, v7
v_cvt_pk_bf16_f32 v17, v8, v9
v_cvt_pk_bf16_f32 v18, v10, v11
v_cvt_pk_bf16_f32 v19, v12, v13
s_lshr_b32 s4, s80, 1
s_lshl_b32 s94, s89, 1
s_add_u32 s94, s94, s4
s_and_b32 s5, s80, 1
s_lshl_b32 s5, s5, 1
s_mul_i32 s96, s4, 16640
s_mul_i32 s7, s5, 4160
s_add_u32 s96, s96, s7
s_add_u32 s96, s96, 118560
s_lshl_b32 s97, s94, 12
s_lshl_b32 s5, s5, 1
s_add_u32 s97, s97, s5
s_add_u32 s97, s97, 2
s_waitcnt vmcnt(9)
s_barrier
ds_read_b64_tr_b16 a[0:1], v3 offset:0
ds_read_b64_tr_b16 a[2:3], v3 offset:4224
ds_read_b64_tr_b16 a[4:5], v3 offset:32
ds_read_b64_tr_b16 a[6:7], v3 offset:4256
ds_read_b64_tr_b16 a[8:9], v3 offset:64
ds_read_b64_tr_b16 a[10:11], v3 offset:4288
ds_read_b64_tr_b16 a[12:13], v3 offset:96
ds_read_b64_tr_b16 a[14:15], v3 offset:4320
ds_read_b64_tr_b16 a[16:17], v3 offset:128
ds_read_b64_tr_b16 a[18:19], v3 offset:4352
ds_read_b64_tr_b16 a[20:21], v3 offset:160
ds_read_b64_tr_b16 a[22:23], v3 offset:4384
ds_read_b64_tr_b16 a[24:25], v3 offset:192
ds_read_b64_tr_b16 a[26:27], v3 offset:4416
s_lshl_b32 s4, s85, 2
s_add_u32 s4, s4, s80
s_mul_i32 s99, s4, 14336
v_lshlrev_b32_e64 v15, 7, v0
s_lshl_b32 s95, s89, 13
s_lshl_b32 s4, s80, 11
s_add_u32 s95, s95, s4
s_waitcnt lgkmcnt(6)
v_mfma_f32_32x32x16_bf16 v[128:143], a[0:3], v[16:19], 0
ds_read_b64_tr_b16 a[28:29], v3 offset:224
ds_read_b64_tr_b16 a[30:31], v3 offset:4448
v_lshlrev_b32 v6, 16, v20
v_lshlrev_b32 v8, 16, v21
v_lshlrev_b32 v10, 16, v22
v_lshlrev_b32 v12, 16, v23
v_and_b32_e64 v7, s88, v20
v_mfma_f32_32x32x16_bf16 v[144:159], a[4:7], v[16:19], 0
ds_read_b64_tr_b16 a[0:1], v3 offset:256
ds_read_b64_tr_b16 a[2:3], v3 offset:4480
s_add_u32 m0, s84, 68096
s_add_u32 s7, s83, 458752
buffer_load_dwordx4 v2, s[48:51], s7 offen offset:0 lds
v_mfma_f32_32x32x16_bf16 v[160:175], a[8:11], v[16:19], 0
ds_read_b64_tr_b16 a[4:5], v3 offset:288
ds_read_b64_tr_b16 a[6:7], v3 offset:4512
v_and_b32 v9, s88, v21
v_and_b32 v11, s88, v22
v_and_b32 v13, s88, v23
v_add_f32 v6, v6, v4
v_add_f32_e64 v8, v8, v4
v_mfma_f32_32x32x16_bf16 v[176:191], a[12:15], v[16:19], 0
ds_read_b64_tr_b16 a[8:9], v3 offset:320
ds_read_b64_tr_b16 a[10:11], v3 offset:4544
s_add_u32 s7, s83, 461280
buffer_load_dwordx4 v2, s[48:51], s7 offen offset:1056 lds
s_waitcnt lgkmcnt(6)
v_mfma_f32_32x32x16_bf16 v[192:207], a[16:19], v[16:19], 0
ds_read_b64_tr_b16 a[12:13], v3 offset:352
ds_read_b64_tr_b16 a[14:15], v3 offset:4576
v_add_f32 v10, v10, v4
v_add_f32 v12, v12, v4
v_add_f32 v7, v7, v4
v_add_f32 v9, v9, v4
v_add_f32 v11, v11, v4
v_mfma_f32_32x32x16_bf16 v[208:223], a[20:23], v[16:19], 0
ds_read_b64_tr_b16 a[16:17], v3 offset:384
ds_read_b64_tr_b16 a[18:19], v3 offset:4608
s_add_u32 s7, s83, 463808
buffer_load_dwordx4 v2, s[48:51], s7 offen offset:2112 lds
v_mfma_f32_32x32x16_bf16 v[224:239], a[24:27], v[16:19], 0
ds_read_b64_tr_b16 a[20:21], v3 offset:416
ds_read_b64_tr_b16 a[22:23], v3 offset:4640
v_add_f32_e64 v13, v13, v4
v_cvt_pk_bf16_f32 v20, v6, v7
v_cvt_pk_bf16_f32 v21, v8, v9
v_cvt_pk_bf16_f32 v22, v10, v11
v_cvt_pk_bf16_f32 v23, v12, v13
v_mfma_f32_32x32x16_bf16 v[240:255], a[28:31], v[16:19], 0
ds_read_b64_tr_b16 a[24:25], v3 offset:448
ds_read_b64_tr_b16 a[26:27], v3 offset:4672
s_add_u32 s7, s83, 466336
buffer_load_dwordx4 v2, s[48:51], s7 offen offset:3168 lds
s_waitcnt lgkmcnt(6)
v_mfma_f32_32x32x16_bf16 v[128:143], a[0:3], v[20:23], v[128:143]
ds_read_b64_tr_b16 a[28:29], v3 offset:480
ds_read_b64_tr_b16 a[30:31], v3 offset:4704
v_lshlrev_b32 v6, 16, v24
v_lshlrev_b32 v8, 16, v25
v_lshlrev_b32 v10, 16, v26
v_lshlrev_b32 v12, 16, v27
v_and_b32 v7, s88, v24
v_mfma_f32_32x32x16_bf16 v[144:159], a[4:7], v[20:23], v[144:159]
ds_read_b64_tr_b16 a[0:1], v3 offset:512
ds_read_b64_tr_b16 a[2:3], v3 offset:4736
s_add_u32 m0, s84, 72320
s_add_u32 s7, s83, 473088
buffer_load_dwordx4 v2, s[48:51], s7 offen offset:0 lds
v_mfma_f32_32x32x16_bf16 v[160:175], a[8:11], v[20:23], v[160:175]
ds_read_b64_tr_b16 a[4:5], v3 offset:544
ds_read_b64_tr_b16 a[6:7], v3 offset:4768
v_and_b32 v9, s88, v25
v_and_b32 v11, s88, v26
v_and_b32 v13, s88, v27
v_add_f32 v6, v6, v4
v_add_f32_e64 v8, v8, v4
v_mfma_f32_32x32x16_bf16 v[176:191], a[12:15], v[20:23], v[176:191]
ds_read_b64_tr_b16 a[8:9], v3 offset:576
ds_read_b64_tr_b16 a[10:11], v3 offset:4800
s_add_u32 s7, s83, 475616
buffer_load_dwordx4 v2, s[48:51], s7 offen offset:1056 lds
s_waitcnt lgkmcnt(6)
v_mfma_f32_32x32x16_bf16 v[192:207], a[16:19], v[20:23], v[192:207]
ds_read_b64_tr_b16 a[12:13], v3 offset:608
ds_read_b64_tr_b16 a[14:15], v3 offset:4832
v_add_f32 v10, v10, v4
v_add_f32 v12, v12, v4
v_add_f32 v7, v7, v4
v_add_f32 v9, v9, v4
v_add_f32 v11, v11, v4
v_mfma_f32_32x32x16_bf16 v[208:223], a[20:23], v[20:23], v[208:223]
ds_read_b64_tr_b16 a[16:17], v3 offset:640
ds_read_b64_tr_b16 a[18:19], v3 offset:4864
s_add_u32 s7, s83, 478144
buffer_load_dwordx4 v2, s[48:51], s7 offen offset:2112 lds
v_mfma_f32_32x32x16_bf16 v[224:239], a[24:27], v[20:23], v[224:239]
ds_read_b64_tr_b16 a[20:21], v3 offset:672
ds_read_b64_tr_b16 a[22:23], v3 offset:4896
v_add_f32_e64 v13, v13, v4
v_cvt_pk_bf16_f32 v24, v6, v7
v_cvt_pk_bf16_f32 v25, v8, v9
v_cvt_pk_bf16_f32 v26, v10, v11
v_cvt_pk_bf16_f32 v27, v12, v13
v_mfma_f32_32x32x16_bf16 v[240:255], a[28:31], v[20:23], v[240:255]
ds_read_b64_tr_b16 a[24:25], v3 offset:704
ds_read_b64_tr_b16 a[26:27], v3 offset:4928
s_add_u32 s7, s83, 480672
buffer_load_dwordx4 v2, s[48:51], s7 offen offset:3168 lds
s_waitcnt lgkmcnt(6)
v_mfma_f32_32x32x16_bf16 v[128:143], a[0:3], v[24:27], v[128:143]
ds_read_b64_tr_b16 a[28:29], v3 offset:736
ds_read_b64_tr_b16 a[30:31], v3 offset:4960
v_lshlrev_b32 v6, 16, v28
v_lshlrev_b32 v8, 16, v29
v_lshlrev_b32 v10, 16, v30
v_lshlrev_b32 v12, 16, v31
v_and_b32 v7, s88, v28
v_mfma_f32_32x32x16_bf16 v[144:159], a[4:7], v[24:27], v[144:159]
ds_read_b64_tr_b16 a[0:1], v3 offset:768
ds_read_b64_tr_b16 a[2:3], v3 offset:4992
s_add_u32 m0, s84, 102144
s_add_u32 s7, s83, 688128
buffer_load_dwordx4 v2, s[48:51], s7 offen offset:0 lds
v_mfma_f32_32x32x16_bf16 v[160:175], a[8:11], v[24:27], v[160:175]
ds_read_b64_tr_b16 a[4:5], v3 offset:800
ds_read_b64_tr_b16 a[6:7], v3 offset:5024
v_and_b32 v9, s88, v29
v_and_b32 v11, s88, v30
v_and_b32 v13, s88, v31
v_add_f32 v6, v6, v4
v_add_f32_e64 v8, v8, v4
v_mfma_f32_32x32x16_bf16 v[176:191], a[12:15], v[24:27], v[176:191]
ds_read_b64_tr_b16 a[8:9], v3 offset:832
ds_read_b64_tr_b16 a[10:11], v3 offset:5056
s_add_u32 s7, s83, 690656
buffer_load_dwordx4 v2, s[48:51], s7 offen offset:1056 lds
s_waitcnt lgkmcnt(6)
v_mfma_f32_32x32x16_bf16 v[192:207], a[16:19], v[24:27], v[192:207]
ds_read_b64_tr_b16 a[12:13], v3 offset:864
ds_read_b64_tr_b16 a[14:15], v3 offset:5088
v_add_f32 v10, v10, v4
v_add_f32 v12, v12, v4
v_add_f32 v7, v7, v4
v_add_f32 v9, v9, v4
v_add_f32 v11, v11, v4
v_mfma_f32_32x32x16_bf16 v[208:223], a[20:23], v[24:27], v[208:223]
ds_read_b64_tr_b16 a[16:17], v3 offset:896
ds_read_b64_tr_b16 a[18:19], v3 offset:5120
s_add_u32 s7, s83, 693184
buffer_load_dwordx4 v2, s[48:51], s7 offen offset:2112 lds
v_mfma_f32_32x32x16_bf16 v[224:239], a[24:27], v[24:27], v[224:239]
ds_read_b64_tr_b16 a[20:21], v3 offset:928
ds_read_b64_tr_b16 a[22:23], v3 offset:5152
v_add_f32_e64 v13, v13, v4
v_cvt_pk_bf16_f32 v28, v6, v7
v_cvt_pk_bf16_f32 v29, v8, v9
v_cvt_pk_bf16_f32 v30, v10, v11
v_cvt_pk_bf16_f32 v31, v12, v13
v_mfma_f32_32x32x16_bf16 v[240:255], a[28:31], v[24:27], v[240:255]
ds_read_b64_tr_b16 a[24:25], v3 offset:960
ds_read_b64_tr_b16 a[26:27], v3 offset:5184
s_add_u32 s7, s83, 695712
buffer_load_dwordx4 v2, s[48:51], s7 offen offset:3168 lds
s_waitcnt lgkmcnt(6)
v_mfma_f32_32x32x16_bf16 v[128:143], a[0:3], v[28:31], v[128:143]
ds_read_b64_tr_b16 a[28:29], v3 offset:992
ds_read_b64_tr_b16 a[30:31], v3 offset:5216
v_lshlrev_b32 v6, 16, v32
v_lshlrev_b32 v8, 16, v33
v_lshlrev_b32 v10, 16, v34
v_lshlrev_b32 v12, 16, v35
v_and_b32 v7, s88, v32
v_mfma_f32_32x32x16_bf16 v[144:159], a[4:7], v[28:31], v[144:159]
s_waitcnt vmcnt(13)
s_barrier
ds_read_b64_tr_b16 a[0:1], v3 offset:34048
ds_read_b64_tr_b16 a[2:3], v3 offset:38272
s_add_u32 m0, s84, 106368
s_add_u32 s7, s83, 702464
buffer_load_dwordx4 v2, s[48:51], s7 offen offset:0 lds
v_mfma_f32_32x32x16_bf16 v[160:175], a[8:11], v[28:31], v[160:175]
ds_read_b64_tr_b16 a[4:5], v3 offset:34080
ds_read_b64_tr_b16 a[6:7], v3 offset:38304
v_and_b32 v9, s88, v33
v_and_b32 v11, s88, v34
v_and_b32 v13, s88, v35
v_add_f32 v6, v6, v4
v_add_f32_e64 v8, v8, v4
v_mfma_f32_32x32x16_bf16 v[176:191], a[12:15], v[28:31], v[176:191]
ds_read_b64_tr_b16 a[8:9], v3 offset:34112
ds_read_b64_tr_b16 a[10:11], v3 offset:38336
s_add_u32 s7, s83, 704992
buffer_load_dwordx4 v2, s[48:51], s7 offen offset:1056 lds
s_waitcnt lgkmcnt(6)
v_mfma_f32_32x32x16_bf16 v[192:207], a[16:19], v[28:31], v[192:207]
ds_read_b64_tr_b16 a[12:13], v3 offset:34144
ds_read_b64_tr_b16 a[14:15], v3 offset:38368
v_add_f32 v10, v10, v4
v_add_f32 v12, v12, v4
v_add_f32 v7, v7, v4
v_add_f32 v9, v9, v4
v_add_f32 v11, v11, v4
v_mfma_f32_32x32x16_bf16 v[208:223], a[20:23], v[28:31], v[208:223]
ds_read_b64_tr_b16 a[16:17], v3 offset:34176
ds_read_b64_tr_b16 a[18:19], v3 offset:38400
s_add_u32 s7, s83, 707520
buffer_load_dwordx4 v2, s[48:51], s7 offen offset:2112 lds
v_mfma_f32_32x32x16_bf16 v[224:239], a[24:27], v[28:31], v[224:239]
ds_read_b64_tr_b16 a[20:21], v3 offset:34208
ds_read_b64_tr_b16 a[22:23], v3 offset:38432
v_add_f32_e64 v13, v13, v4
v_cvt_pk_bf16_f32 v32, v6, v7
v_cvt_pk_bf16_f32 v33, v8, v9
v_cvt_pk_bf16_f32 v34, v10, v11
v_cvt_pk_bf16_f32 v35, v12, v13
v_mfma_f32_32x32x16_bf16 v[240:255], a[28:31], v[28:31], v[240:255]
ds_read_b64_tr_b16 a[24:25], v3 offset:34240
ds_read_b64_tr_b16 a[26:27], v3 offset:38464
s_add_u32 s7, s83, 710048
buffer_load_dwordx4 v2, s[48:51], s7 offen offset:3168 lds
s_waitcnt lgkmcnt(6)
v_mfma_f32_32x32x16_bf16 v[128:143], a[0:3], v[32:35], v[128:143]
ds_read_b64_tr_b16 a[28:29], v3 offset:34272
ds_read_b64_tr_b16 a[30:31], v3 offset:38496
v_lshlrev_b32 v6, 16, v36
v_lshlrev_b32 v8, 16, v37
v_lshlrev_b32 v10, 16, v38
v_lshlrev_b32_e64 v12, 16, v39
v_mfma_f32_32x32x16_bf16 v[144:159], a[4:7], v[32:35], v[144:159]
ds_read_b64_tr_b16 a[0:1], v3 offset:34304
ds_read_b64_tr_b16 a[2:3], v3 offset:38528
v_and_b32 v7, s88, v36
v_and_b32 v9, s88, v37
v_and_b32_e64 v11, s88, v38
v_mfma_f32_32x32x16_bf16 v[160:175], a[8:11], v[32:35], v[160:175]
ds_read_b64_tr_b16 a[4:5], v3 offset:34336
ds_read_b64_tr_b16 a[6:7], v3 offset:38560
v_and_b32 v13, s88, v39
v_add_f32 v6, v6, v4
v_add_f32_e64 v8, v8, v4
v_mfma_f32_32x32x16_bf16 v[176:191], a[12:15], v[32:35], v[176:191]
ds_read_b64_tr_b16 a[8:9], v3 offset:34368
ds_read_b64_tr_b16 a[10:11], v3 offset:38592
s_add_u32 m0, s84, 0
s_add_u32 s7, s83, 917504
buffer_load_dwordx4 v2, s[48:51], s7 offen offset:0 lds
s_waitcnt lgkmcnt(6)
v_mfma_f32_32x32x16_bf16 v[192:207], a[16:19], v[32:35], v[192:207]
ds_read_b64_tr_b16 a[12:13], v3 offset:34400
ds_read_b64_tr_b16 a[14:15], v3 offset:38624
v_add_f32 v10, v10, v4
v_add_f32 v12, v12, v4
v_add_f32 v7, v7, v4
v_add_f32 v9, v9, v4
v_mfma_f32_32x32x16_bf16 v[208:223], a[20:23], v[32:35], v[208:223]
ds_read_b64_tr_b16 a[16:17], v3 offset:34432
ds_read_b64_tr_b16 a[18:19], v3 offset:38656
v_add_f32 v11, v11, v4
v_add_f32 v13, v13, v4
v_cvt_pk_bf16_f32 v36, v6, v7
v_mfma_f32_32x32x16_bf16 v[224:239], a[24:27], v[32:35], v[224:239]
ds_read_b64_tr_b16 a[20:21], v3 offset:34464
ds_read_b64_tr_b16 a[22:23], v3 offset:38688
v_cvt_pk_bf16_f32 v37, v8, v9
v_cvt_pk_bf16_f32 v38, v10, v11
v_cvt_pk_bf16_f32 v39, v12, v13
v_mfma_f32_32x32x16_bf16 v[240:255], a[28:31], v[32:35], v[240:255]
ds_read_b64_tr_b16 a[24:25], v3 offset:34496
ds_read_b64_tr_b16 a[26:27], v3 offset:38720
s_add_u32 s7, s83, 920032
buffer_load_dwordx4 v2, s[48:51], s7 offen offset:1056 lds
s_waitcnt lgkmcnt(6)
v_mfma_f32_32x32x16_bf16 v[128:143], a[0:3], v[36:39], v[128:143]
ds_read_b64_tr_b16 a[28:29], v3 offset:34528
ds_read_b64_tr_b16 a[30:31], v3 offset:38752
v_lshlrev_b32 v6, 16, v40
v_lshlrev_b32 v8, 16, v41
v_lshlrev_b32 v10, 16, v42
v_lshlrev_b32_e64 v12, 16, v43
v_mfma_f32_32x32x16_bf16 v[144:159], a[4:7], v[36:39], v[144:159]
ds_read_b64_tr_b16 a[0:1], v3 offset:34560
ds_read_b64_tr_b16 a[2:3], v3 offset:38784
v_and_b32 v7, s88, v40
v_and_b32 v9, s88, v41
v_and_b32_e64 v11, s88, v42
v_mfma_f32_32x32x16_bf16 v[160:175], a[8:11], v[36:39], v[160:175]
ds_read_b64_tr_b16 a[4:5], v3 offset:34592
ds_read_b64_tr_b16 a[6:7], v3 offset:38816
v_and_b32 v13, s88, v43
v_add_f32 v6, v6, v4
v_add_f32_e64 v8, v8, v4
v_mfma_f32_32x32x16_bf16 v[176:191], a[12:15], v[36:39], v[176:191]
ds_read_b64_tr_b16 a[8:9], v3 offset:34624
ds_read_b64_tr_b16 a[10:11], v3 offset:38848
s_add_u32 s7, s83, 922560
buffer_load_dwordx4 v2, s[48:51], s7 offen offset:2112 lds
s_waitcnt lgkmcnt(6)
v_mfma_f32_32x32x16_bf16 v[192:207], a[16:19], v[36:39], v[192:207]
ds_read_b64_tr_b16 a[12:13], v3 offset:34656
ds_read_b64_tr_b16 a[14:15], v3 offset:38880
v_add_f32 v10, v10, v4
v_add_f32 v12, v12, v4
v_add_f32 v7, v7, v4
v_add_f32_e64 v9, v9, v4
v_mfma_f32_32x32x16_bf16 v[208:223], a[20:23], v[36:39], v[208:223]
ds_read_b64_tr_b16 a[16:17], v3 offset:34688
ds_read_b64_tr_b16 a[18:19], v3 offset:38912
v_add_f32 v11, v11, v4
v_add_f32 v13, v13, v4
v_cvt_pk_bf16_f32 v40, v6, v7
v_mfma_f32_32x32x16_bf16 v[224:239], a[24:27], v[36:39], v[224:239]
ds_read_b64_tr_b16 a[20:21], v3 offset:34720
ds_read_b64_tr_b16 a[22:23], v3 offset:38944
v_cvt_pk_bf16_f32 v41, v8, v9
v_cvt_pk_bf16_f32 v42, v10, v11
v_cvt_pk_bf16_f32 v43, v12, v13
v_mfma_f32_32x32x16_bf16 v[240:255], a[28:31], v[36:39], v[240:255]
ds_read_b64_tr_b16 a[24:25], v3 offset:34752
ds_read_b64_tr_b16 a[26:27], v3 offset:38976
s_add_u32 s7, s83, 925088
buffer_load_dwordx4 v2, s[48:51], s7 offen offset:3168 lds
s_waitcnt lgkmcnt(6)
v_mfma_f32_32x32x16_bf16 v[128:143], a[0:3], v[40:43], v[128:143]
ds_read_b64_tr_b16 a[28:29], v3 offset:34784
ds_read_b64_tr_b16 a[30:31], v3 offset:39008
v_lshlrev_b32 v6, 16, v44
v_lshlrev_b32 v8, 16, v45
v_lshlrev_b32 v10, 16, v46
v_lshlrev_b32_e64 v12, 16, v47
v_mfma_f32_32x32x16_bf16 v[144:159], a[4:7], v[40:43], v[144:159]
ds_read_b64_tr_b16 a[0:1], v3 offset:34816
ds_read_b64_tr_b16 a[2:3], v3 offset:39040
v_and_b32 v7, s88, v44
v_and_b32 v9, s88, v45
v_and_b32_e64 v11, s88, v46
v_mfma_f32_32x32x16_bf16 v[160:175], a[8:11], v[40:43], v[160:175]
ds_read_b64_tr_b16 a[4:5], v3 offset:34848
ds_read_b64_tr_b16 a[6:7], v3 offset:39072
v_and_b32 v13, s88, v47
v_add_f32 v6, v6, v4
v_add_f32_e64 v8, v8, v4
v_mfma_f32_32x32x16_bf16 v[176:191], a[12:15], v[40:43], v[176:191]
ds_read_b64_tr_b16 a[8:9], v3 offset:34880
ds_read_b64_tr_b16 a[10:11], v3 offset:39104
s_add_u32 m0, s84, 4224
s_add_u32 s7, s83, 931840
buffer_load_dwordx4 v2, s[48:51], s7 offen offset:0 lds
s_waitcnt lgkmcnt(6)
v_mfma_f32_32x32x16_bf16 v[192:207], a[16:19], v[40:43], v[192:207]
ds_read_b64_tr_b16 a[12:13], v3 offset:34912
ds_read_b64_tr_b16 a[14:15], v3 offset:39136
v_add_f32 v10, v10, v4
v_add_f32 v12, v12, v4
v_add_f32 v7, v7, v4
v_add_f32_e64 v9, v9, v4
v_mfma_f32_32x32x16_bf16 v[208:223], a[20:23], v[40:43], v[208:223]
ds_read_b64_tr_b16 a[16:17], v3 offset:34944
ds_read_b64_tr_b16 a[18:19], v3 offset:39168
v_add_f32 v11, v11, v4
v_add_f32 v13, v13, v4
v_cvt_pk_bf16_f32 v44, v6, v7
v_mfma_f32_32x32x16_bf16 v[224:239], a[24:27], v[40:43], v[224:239]
ds_read_b64_tr_b16 a[20:21], v3 offset:34976
ds_read_b64_tr_b16 a[22:23], v3 offset:39200
v_cvt_pk_bf16_f32 v45, v8, v9
v_cvt_pk_bf16_f32 v46, v10, v11
v_cvt_pk_bf16_f32 v47, v12, v13
v_mfma_f32_32x32x16_bf16 v[240:255], a[28:31], v[40:43], v[240:255]
ds_read_b64_tr_b16 a[24:25], v3 offset:35008
ds_read_b64_tr_b16 a[26:27], v3 offset:39232
s_add_u32 s7, s83, 934368
buffer_load_dwordx4 v2, s[48:51], s7 offen offset:1056 lds
s_waitcnt lgkmcnt(6)
v_mfma_f32_32x32x16_bf16 v[128:143], a[0:3], v[44:47], v[128:143]
ds_read_b64_tr_b16 a[28:29], v3 offset:35040
ds_read_b64_tr_b16 a[30:31], v3 offset:39264
v_lshlrev_b32 v6, 16, v48
v_lshlrev_b32 v8, 16, v49
v_lshlrev_b32 v10, 16, v50
v_lshlrev_b32 v12, 16, v51
v_mfma_f32_32x32x16_bf16 v[144:159], a[4:7], v[44:47], v[144:159]
s_waitcnt vmcnt(14)
s_barrier
ds_read_b64_tr_b16 a[0:1], v14 offset:0
ds_read_b64_tr_b16 a[2:3], v14 offset:4224
v_and_b32 v7, s88, v48
v_and_b32 v9, s88, v49
v_and_b32 v11, s88, v50
v_mfma_f32_32x32x16_bf16 v[160:175], a[8:11], v[44:47], v[160:175]
ds_read_b64_tr_b16 a[4:5], v14 offset:32
ds_read_b64_tr_b16 a[6:7], v14 offset:4256
v_and_b32 v13, s88, v51
v_add_f32 v6, v6, v4
v_add_f32_e64 v8, v8, v4
v_mfma_f32_32x32x16_bf16 v[176:191], a[12:15], v[44:47], v[176:191]
ds_read_b64_tr_b16 a[8:9], v14 offset:64
ds_read_b64_tr_b16 a[10:11], v14 offset:4288
s_add_u32 s7, s83, 936896
buffer_load_dwordx4 v2, s[48:51], s7 offen offset:2112 lds
s_waitcnt lgkmcnt(6)
v_mfma_f32_32x32x16_bf16 v[192:207], a[16:19], v[44:47], v[192:207]
ds_read_b64_tr_b16 a[12:13], v14 offset:96
ds_read_b64_tr_b16 a[14:15], v14 offset:4320
v_add_f32 v10, v10, v4
v_add_f32 v12, v12, v4
v_add_f32 v7, v7, v4
v_add_f32_e64 v9, v9, v4
v_mfma_f32_32x32x16_bf16 v[208:223], a[20:23], v[44:47], v[208:223]
ds_read_b64_tr_b16 a[16:17], v14 offset:128
ds_read_b64_tr_b16 a[18:19], v14 offset:4352
v_add_f32 v11, v11, v4
v_add_f32 v13, v13, v4
v_cvt_pk_bf16_f32 v48, v6, v7
v_mfma_f32_32x32x16_bf16 v[224:239], a[24:27], v[44:47], v[224:239]
ds_read_b64_tr_b16 a[20:21], v14 offset:160
ds_read_b64_tr_b16 a[22:23], v14 offset:4384
v_cvt_pk_bf16_f32 v49, v8, v9
v_cvt_pk_bf16_f32 v50, v10, v11
v_cvt_pk_bf16_f32 v51, v12, v13
v_mfma_f32_32x32x16_bf16 v[240:255], a[28:31], v[44:47], v[240:255]
ds_read_b64_tr_b16 a[24:25], v14 offset:192
ds_read_b64_tr_b16 a[26:27], v14 offset:4416
s_add_u32 s7, s83, 939424
buffer_load_dwordx4 v2, s[48:51], s7 offen offset:3168 lds
s_waitcnt lgkmcnt(6)
v_mfma_f32_32x32x16_bf16 v[128:143], a[0:3], v[48:51], v[128:143]
ds_read_b64_tr_b16 a[28:29], v14 offset:224
ds_read_b64_tr_b16 a[30:31], v14 offset:4448
v_lshlrev_b32 v6, 16, v52
v_lshlrev_b32 v8, 16, v53
v_lshlrev_b32 v10, 16, v54
v_lshlrev_b32_e64 v12, 16, v55
v_mfma_f32_32x32x16_bf16 v[144:159], a[4:7], v[48:51], v[144:159]
ds_read_b64_tr_b16 a[0:1], v14 offset:256
ds_read_b64_tr_b16 a[2:3], v14 offset:4480
v_and_b32 v7, s88, v52
v_and_b32 v9, s88, v53
v_and_b32 v11, s88, v54
v_and_b32 v13, s88, v55
v_mfma_f32_32x32x16_bf16 v[160:175], a[8:11], v[48:51], v[160:175]
ds_read_b64_tr_b16 a[4:5], v14 offset:288
ds_read_b64_tr_b16 a[6:7], v14 offset:4512
s_add_u32 m0, s84, 34048
s_add_u32 s7, s83, 1146880
buffer_load_dwordx4 v2, s[48:51], s7 offen offset:0 lds
v_mfma_f32_32x32x16_bf16 v[176:191], a[12:15], v[48:51], v[176:191]
ds_read_b64_tr_b16 a[8:9], v14 offset:320
ds_read_b64_tr_b16 a[10:11], v14 offset:4544
v_add_f32 v6, v6, v4
v_add_f32 v8, v8, v4
v_add_f32 v10, v10, v4
v_add_f32_e64 v12, v12, v4
s_waitcnt lgkmcnt(6)
v_mfma_f32_32x32x16_bf16 v[192:207], a[16:19], v[48:51], v[192:207]
ds_read_b64_tr_b16 a[12:13], v14 offset:352
ds_read_b64_tr_b16 a[14:15], v14 offset:4576
v_add_f32 v7, v7, v4
v_add_f32 v9, v9, v4
v_add_f32 v11, v11, v4
v_add_f32 v13, v13, v4
v_mfma_f32_32x32x16_bf16 v[208:223], a[20:23], v[48:51], v[208:223]
ds_read_b64_tr_b16 a[16:17], v14 offset:384
ds_read_b64_tr_b16 a[18:19], v14 offset:4608
s_add_u32 s7, s83, 1149408
buffer_load_dwordx4 v2, s[48:51], s7 offen offset:1056 lds
v_mfma_f32_32x32x16_bf16 v[224:239], a[24:27], v[48:51], v[224:239]
ds_read_b64_tr_b16 a[20:21], v14 offset:416
ds_read_b64_tr_b16 a[22:23], v14 offset:4640
v_cvt_pk_bf16_f32 v52, v6, v7
v_cvt_pk_bf16_f32 v53, v8, v9
v_cvt_pk_bf16_f32 v54, v10, v11
v_cvt_pk_bf16_f32 v55, v12, v13
v_mfma_f32_32x32x16_bf16 v[240:255], a[28:31], v[48:51], v[240:255]
ds_read_b64_tr_b16 a[24:25], v14 offset:448
ds_read_b64_tr_b16 a[26:27], v14 offset:4672
s_mov_b64 exec, 0xffff
buffer_load_dword a250, v15, s[60:63], s95 offen
s_mov_b64 exec, -1
s_waitcnt lgkmcnt(6)
v_mfma_f32_32x32x16_bf16 v[128:143], a[0:3], v[52:55], v[128:143]
ds_read_b64_tr_b16 a[28:29], v14 offset:480
ds_read_b64_tr_b16 a[30:31], v14 offset:4704
v_lshlrev_b32 v6, 16, v56
v_lshlrev_b32 v8, 16, v57
v_lshlrev_b32 v10, 16, v58
v_lshlrev_b32 v12, 16, v59
v_mfma_f32_32x32x16_bf16 v[144:159], a[4:7], v[52:55], v[144:159]
ds_read_b64_tr_b16 a[0:1], v14 offset:512
ds_read_b64_tr_b16 a[2:3], v14 offset:4736
v_and_b32 v7, s88, v56
v_and_b32 v9, s88, v57
v_and_b32 v11, s88, v58
v_and_b32 v13, s88, v59
v_mfma_f32_32x32x16_bf16 v[160:175], a[8:11], v[52:55], v[160:175]
ds_read_b64_tr_b16 a[4:5], v14 offset:544
ds_read_b64_tr_b16 a[6:7], v14 offset:4768
s_add_u32 s7, s83, 1151936
buffer_load_dwordx4 v2, s[48:51], s7 offen offset:2112 lds
v_mfma_f32_32x32x16_bf16 v[176:191], a[12:15], v[52:55], v[176:191]
ds_read_b64_tr_b16 a[8:9], v14 offset:576
ds_read_b64_tr_b16 a[10:11], v14 offset:4800
v_add_f32 v6, v6, v4
v_add_f32 v8, v8, v4
v_add_f32 v10, v10, v4
v_add_f32_e64 v12, v12, v4
s_waitcnt lgkmcnt(6)
v_mfma_f32_32x32x16_bf16 v[192:207], a[16:19], v[52:55], v[192:207]
ds_read_b64_tr_b16 a[12:13], v14 offset:608
ds_read_b64_tr_b16 a[14:15], v14 offset:4832
v_add_f32 v7, v7, v4
v_add_f32 v9, v9, v4
v_add_f32 v11, v11, v4
v_add_f32 v13, v13, v4
v_mfma_f32_32x32x16_bf16 v[208:223], a[20:23], v[52:55], v[208:223]
ds_read_b64_tr_b16 a[16:17], v14 offset:640
ds_read_b64_tr_b16 a[18:19], v14 offset:4864
s_add_u32 s7, s83, 1154464
buffer_load_dwordx4 v2, s[48:51], s7 offen offset:3168 lds
v_mfma_f32_32x32x16_bf16 v[224:239], a[24:27], v[52:55], v[224:239]
ds_read_b64_tr_b16 a[20:21], v14 offset:672
ds_read_b64_tr_b16 a[22:23], v14 offset:4896
v_cvt_pk_bf16_f32 v56, v6, v7
v_cvt_pk_bf16_f32 v57, v8, v9
v_cvt_pk_bf16_f32 v58, v10, v11
v_cvt_pk_bf16_f32 v59, v12, v13
v_mfma_f32_32x32x16_bf16 v[240:255], a[28:31], v[52:55], v[240:255]
ds_read_b64_tr_b16 a[24:25], v14 offset:704
ds_read_b64_tr_b16 a[26:27], v14 offset:4928
s_mov_b64 exec, 0xffff
buffer_load_dword a250, v15, s[56:59], s99 offen offset:0
s_mov_b64 exec, -1
s_waitcnt lgkmcnt(6)
v_mfma_f32_32x32x16_bf16 v[128:143], a[0:3], v[56:59], v[128:143]
ds_read_b64_tr_b16 a[28:29], v14 offset:736
ds_read_b64_tr_b16 a[30:31], v14 offset:4960
v_lshlrev_b32 v6, 16, v60
v_lshlrev_b32 v8, 16, v61
v_lshlrev_b32 v10, 16, v62
v_lshlrev_b32 v12, 16, v63
v_mfma_f32_32x32x16_bf16 v[144:159], a[4:7], v[56:59], v[144:159]
ds_read_b64_tr_b16 a[0:1], v14 offset:768
ds_read_b64_tr_b16 a[2:3], v14 offset:4992
v_and_b32 v7, s88, v60
v_and_b32 v9, s88, v61
v_and_b32 v11, s88, v62
v_and_b32 v13, s88, v63
v_mfma_f32_32x32x16_bf16 v[160:175], a[8:11], v[56:59], v[160:175]
ds_read_b64_tr_b16 a[4:5], v14 offset:800
ds_read_b64_tr_b16 a[6:7], v14 offset:5024
s_add_u32 m0, s84, 38272
s_add_u32 s7, s83, 1161216
buffer_load_dwordx4 v2, s[48:51], s7 offen offset:0 lds
v_mfma_f32_32x32x16_bf16 v[176:191], a[12:15], v[56:59], v[176:191]
ds_read_b64_tr_b16 a[8:9], v14 offset:832
ds_read_b64_tr_b16 a[10:11], v14 offset:5056
v_add_f32 v6, v6, v4
v_add_f32 v8, v8, v4
v_add_f32 v10, v10, v4
v_add_f32_e64 v12, v12, v4
s_waitcnt lgkmcnt(6)
v_mfma_f32_32x32x16_bf16 v[192:207], a[16:19], v[56:59], v[192:207]
ds_read_b64_tr_b16 a[12:13], v14 offset:864
ds_read_b64_tr_b16 a[14:15], v14 offset:5088
v_add_f32 v7, v7, v4
v_add_f32 v9, v9, v4
v_add_f32 v11, v11, v4
v_add_f32 v13, v13, v4
v_mfma_f32_32x32x16_bf16 v[208:223], a[20:23], v[56:59], v[208:223]
ds_read_b64_tr_b16 a[16:17], v14 offset:896
ds_read_b64_tr_b16 a[18:19], v14 offset:5120
s_add_u32 s7, s83, 1163744
buffer_load_dwordx4 v2, s[48:51], s7 offen offset:1056 lds
v_mfma_f32_32x32x16_bf16 v[224:239], a[24:27], v[56:59], v[224:239]
ds_read_b64_tr_b16 a[20:21], v14 offset:928
ds_read_b64_tr_b16 a[22:23], v14 offset:5152
v_cvt_pk_bf16_f32 v60, v6, v7
v_cvt_pk_bf16_f32 v61, v8, v9
v_cvt_pk_bf16_f32 v62, v10, v11
v_cvt_pk_bf16_f32 v63, v12, v13
v_mfma_f32_32x32x16_bf16 v[240:255], a[28:31], v[56:59], v[240:255]
ds_read_b64_tr_b16 a[24:25], v14 offset:960
ds_read_b64_tr_b16 a[26:27], v14 offset:5184
s_mov_b64 exec, 0xffff
buffer_load_dword a250, v15, s[56:59], s99 offen offset:2048
s_mov_b64 exec, -1
s_waitcnt lgkmcnt(6)
v_mfma_f32_32x32x16_bf16 v[128:143], a[0:3], v[60:63], v[128:143]
ds_read_b64_tr_b16 a[28:29], v14 offset:992
ds_read_b64_tr_b16 a[30:31], v14 offset:5216
v_lshlrev_b32 v6, 16, v64
v_lshlrev_b32 v8, 16, v65
v_lshlrev_b32 v10, 16, v66
v_lshlrev_b32 v12, 16, v67
v_mfma_f32_32x32x16_bf16 v[144:159], a[4:7], v[60:63], v[144:159]
s_waitcnt vmcnt(17)
s_barrier
ds_read_b64_tr_b16 a[0:1], v14 offset:34048
ds_read_b64_tr_b16 a[2:3], v14 offset:38272
v_and_b32 v7, s88, v64
v_and_b32 v9, s88, v65
v_and_b32 v11, s88, v66
v_and_b32 v13, s88, v67
v_mfma_f32_32x32x16_bf16 v[160:175], a[8:11], v[60:63], v[160:175]
ds_read_b64_tr_b16 a[4:5], v14 offset:34080
ds_read_b64_tr_b16 a[6:7], v14 offset:38304
s_add_u32 s7, s83, 1166272
buffer_load_dwordx4 v2, s[48:51], s7 offen offset:2112 lds
v_mfma_f32_32x32x16_bf16 v[176:191], a[12:15], v[60:63], v[176:191]
ds_read_b64_tr_b16 a[8:9], v14 offset:34112
ds_read_b64_tr_b16 a[10:11], v14 offset:38336
v_add_f32 v6, v6, v4
v_add_f32 v8, v8, v4
v_add_f32 v10, v10, v4
v_add_f32_e64 v12, v12, v4
s_waitcnt lgkmcnt(6)
v_mfma_f32_32x32x16_bf16 v[192:207], a[16:19], v[60:63], v[192:207]
ds_read_b64_tr_b16 a[12:13], v14 offset:34144
ds_read_b64_tr_b16 a[14:15], v14 offset:38368
v_add_f32 v7, v7, v4
v_add_f32 v9, v9, v4
v_add_f32 v11, v11, v4
v_add_f32 v13, v13, v4
v_mfma_f32_32x32x16_bf16 v[208:223], a[20:23], v[60:63], v[208:223]
ds_read_b64_tr_b16 a[16:17], v14 offset:34176
ds_read_b64_tr_b16 a[18:19], v14 offset:38400
s_add_u32 s7, s83, 1168800
buffer_load_dwordx4 v2, s[48:51], s7 offen offset:3168 lds
v_mfma_f32_32x32x16_bf16 v[224:239], a[24:27], v[60:63], v[224:239]
ds_read_b64_tr_b16 a[20:21], v14 offset:34208
ds_read_b64_tr_b16 a[22:23], v14 offset:38432
v_cvt_pk_bf16_f32 v64, v6, v7
v_cvt_pk_bf16_f32 v65, v8, v9
v_cvt_pk_bf16_f32 v66, v10, v11
v_cvt_pk_bf16_f32 v67, v12, v13
v_mfma_f32_32x32x16_bf16 v[240:255], a[28:31], v[60:63], v[240:255]
ds_read_b64_tr_b16 a[24:25], v14 offset:34240
ds_read_b64_tr_b16 a[26:27], v14 offset:38464
s_add_u32 s99, s99, 2048
s_mov_b64 exec, 0xffff
buffer_load_dword a250, v15, s[56:59], s99 offen offset:2048
s_mov_b64 exec, -1
s_waitcnt lgkmcnt(6)
v_mfma_f32_32x32x16_bf16 v[128:143], a[0:3], v[64:67], v[128:143]
ds_read_b64_tr_b16 a[28:29], v14 offset:34272
ds_read_b64_tr_b16 a[30:31], v14 offset:38496
v_lshlrev_b32 v6, 16, v68
v_lshlrev_b32 v8, 16, v69
v_lshlrev_b32 v10, 16, v70
v_lshlrev_b32 v12, 16, v71
v_mfma_f32_32x32x16_bf16 v[144:159], a[4:7], v[64:67], v[144:159]
ds_read_b64_tr_b16 a[0:1], v14 offset:34304
ds_read_b64_tr_b16 a[2:3], v14 offset:38528
v_and_b32 v7, s88, v68
v_and_b32 v9, s88, v69
v_and_b32 v11, s88, v70
v_and_b32 v13, s88, v71
v_mfma_f32_32x32x16_bf16 v[160:175], a[8:11], v[64:67], v[160:175]
ds_read_b64_tr_b16 a[4:5], v14 offset:34336
ds_read_b64_tr_b16 a[6:7], v14 offset:38560
s_add_u32 m0, s84, 68096
s_add_u32 s7, s83, 1376256
buffer_load_dwordx4 v2, s[48:51], s7 offen offset:0 lds
v_mfma_f32_32x32x16_bf16 v[176:191], a[12:15], v[64:67], v[176:191]
ds_read_b64_tr_b16 a[8:9], v14 offset:34368
ds_read_b64_tr_b16 a[10:11], v14 offset:38592
v_add_f32 v6, v6, v4
v_add_f32 v8, v8, v4
v_add_f32 v10, v10, v4
v_add_f32_e64 v12, v12, v4
s_waitcnt lgkmcnt(6)
v_mfma_f32_32x32x16_bf16 v[192:207], a[16:19], v[64:67], v[192:207]
ds_read_b64_tr_b16 a[12:13], v14 offset:34400
ds_read_b64_tr_b16 a[14:15], v14 offset:38624
v_add_f32 v7, v7, v4
v_add_f32 v9, v9, v4
v_add_f32 v11, v11, v4
v_add_f32 v13, v13, v4
v_mfma_f32_32x32x16_bf16 v[208:223], a[20:23], v[64:67], v[208:223]
ds_read_b64_tr_b16 a[16:17], v14 offset:34432
ds_read_b64_tr_b16 a[18:19], v14 offset:38656
s_add_u32 s7, s83, 1378784
buffer_load_dwordx4 v2, s[48:51], s7 offen offset:1056 lds
v_mfma_f32_32x32x16_bf16 v[224:239], a[24:27], v[64:67], v[224:239]
ds_read_b64_tr_b16 a[20:21], v14 offset:34464
ds_read_b64_tr_b16 a[22:23], v14 offset:38688
v_cvt_pk_bf16_f32 v68, v6, v7
v_cvt_pk_bf16_f32 v69, v8, v9
v_cvt_pk_bf16_f32 v70, v10, v11
v_cvt_pk_bf16_f32 v71, v12, v13
v_mfma_f32_32x32x16_bf16 v[240:255], a[28:31], v[64:67], v[240:255]
ds_read_b64_tr_b16 a[24:25], v14 offset:34496
ds_read_b64_tr_b16 a[26:27], v14 offset:38720
s_add_u32 s99, s99, 2048
s_mov_b64 exec, 0xffff
buffer_load_dword a250, v15, s[56:59], s99 offen offset:2048
s_mov_b64 exec, -1
s_waitcnt lgkmcnt(6)
v_mfma_f32_32x32x16_bf16 v[128:143], a[0:3], v[68:71], v[128:143]
ds_read_b64_tr_b16 a[28:29], v14 offset:34528
ds_read_b64_tr_b16 a[30:31], v14 offset:38752
v_lshlrev_b32 v6, 16, v72
v_lshlrev_b32 v8, 16, v73
v_lshlrev_b32 v10, 16, v74
v_lshlrev_b32 v12, 16, v75
v_mfma_f32_32x32x16_bf16 v[144:159], a[4:7], v[68:71], v[144:159]
ds_read_b64_tr_b16 a[0:1], v14 offset:34560
ds_read_b64_tr_b16 a[2:3], v14 offset:38784
v_and_b32 v7, s88, v72
v_and_b32 v9, s88, v73
v_and_b32 v11, s88, v74
v_and_b32 v13, s88, v75
v_mfma_f32_32x32x16_bf16 v[160:175], a[8:11], v[68:71], v[160:175]
ds_read_b64_tr_b16 a[4:5], v14 offset:34592
ds_read_b64_tr_b16 a[6:7], v14 offset:38816
s_add_u32 s7, s83, 1381312
buffer_load_dwordx4 v2, s[48:51], s7 offen offset:2112 lds
v_mfma_f32_32x32x16_bf16 v[176:191], a[12:15], v[68:71], v[176:191]
ds_read_b64_tr_b16 a[8:9], v14 offset:34624
ds_read_b64_tr_b16 a[10:11], v14 offset:38848
v_add_f32 v6, v6, v4
v_add_f32 v8, v8, v4
v_add_f32 v10, v10, v4
v_add_f32_e64 v12, v12, v4
s_waitcnt lgkmcnt(6)
v_mfma_f32_32x32x16_bf16 v[192:207], a[16:19], v[68:71], v[192:207]
ds_read_b64_tr_b16 a[12:13], v14 offset:34656
ds_read_b64_tr_b16 a[14:15], v14 offset:38880
v_add_f32 v7, v7, v4
v_add_f32 v9, v9, v4
v_add_f32 v11, v11, v4
v_add_f32 v13, v13, v4
v_mfma_f32_32x32x16_bf16 v[208:223], a[20:23], v[68:71], v[208:223]
ds_read_b64_tr_b16 a[16:17], v14 offset:34688
ds_read_b64_tr_b16 a[18:19], v14 offset:38912
s_add_u32 s7, s83, 1383840
buffer_load_dwordx4 v2, s[48:51], s7 offen offset:3168 lds
v_mfma_f32_32x32x16_bf16 v[224:239], a[24:27], v[68:71], v[224:239]
ds_read_b64_tr_b16 a[20:21], v14 offset:34720
ds_read_b64_tr_b16 a[22:23], v14 offset:38944
v_cvt_pk_bf16_f32 v72, v6, v7
v_cvt_pk_bf16_f32 v73, v8, v9
v_cvt_pk_bf16_f32 v74, v10, v11
v_cvt_pk_bf16_f32 v75, v12, v13
v_mfma_f32_32x32x16_bf16 v[240:255], a[28:31], v[68:71], v[240:255]
ds_read_b64_tr_b16 a[24:25], v14 offset:34752
ds_read_b64_tr_b16 a[26:27], v14 offset:38976
s_add_u32 s99, s99, 2048
s_mov_b64 exec, 0xffff
buffer_load_dword a250, v15, s[56:59], s99 offen offset:2048
s_mov_b64 exec, -1
s_waitcnt lgkmcnt(6)
v_mfma_f32_32x32x16_bf16 v[128:143], a[0:3], v[72:75], v[128:143]
ds_read_b64_tr_b16 a[28:29], v14 offset:34784
ds_read_b64_tr_b16 a[30:31], v14 offset:39008
v_lshlrev_b32 v6, 16, v76
v_lshlrev_b32 v8, 16, v77
v_lshlrev_b32 v10, 16, v78
v_lshlrev_b32 v12, 16, v79
v_mfma_f32_32x32x16_bf16 v[144:159], a[4:7], v[72:75], v[144:159]
ds_read_b64_tr_b16 a[0:1], v14 offset:34816
ds_read_b64_tr_b16 a[2:3], v14 offset:39040
v_and_b32 v7, s88, v76
v_and_b32 v9, s88, v77
v_and_b32 v11, s88, v78
v_and_b32 v13, s88, v79
v_mfma_f32_32x32x16_bf16 v[160:175], a[8:11], v[72:75], v[160:175]
ds_read_b64_tr_b16 a[4:5], v14 offset:34848
ds_read_b64_tr_b16 a[6:7], v14 offset:39072
s_add_u32 m0, s84, 72320
s_add_u32 s7, s83, 1390592
buffer_load_dwordx4 v2, s[48:51], s7 offen offset:0 lds
v_mfma_f32_32x32x16_bf16 v[176:191], a[12:15], v[72:75], v[176:191]
ds_read_b64_tr_b16 a[8:9], v14 offset:34880
ds_read_b64_tr_b16 a[10:11], v14 offset:39104
v_add_f32 v6, v6, v4
v_add_f32 v8, v8, v4
v_add_f32 v10, v10, v4
v_add_f32_e64 v12, v12, v4
s_waitcnt lgkmcnt(6)
v_mfma_f32_32x32x16_bf16 v[192:207], a[16:19], v[72:75], v[192:207]
ds_read_b64_tr_b16 a[12:13], v14 offset:34912
ds_read_b64_tr_b16 a[14:15], v14 offset:39136
v_add_f32 v7, v7, v4
v_add_f32 v9, v9, v4
v_add_f32 v11, v11, v4
v_add_f32 v13, v13, v4
v_mfma_f32_32x32x16_bf16 v[208:223], a[20:23], v[72:75], v[208:223]
ds_read_b64_tr_b16 a[16:17], v14 offset:34944
ds_read_b64_tr_b16 a[18:19], v14 offset:39168
s_add_u32 s7, s83, 1393120
buffer_load_dwordx4 v2, s[48:51], s7 offen offset:1056 lds
v_mfma_f32_32x32x16_bf16 v[224:239], a[24:27], v[72:75], v[224:239]
ds_read_b64_tr_b16 a[20:21], v14 offset:34976
ds_read_b64_tr_b16 a[22:23], v14 offset:39200
v_cvt_pk_bf16_f32 v76, v6, v7
v_cvt_pk_bf16_f32 v77, v8, v9
v_cvt_pk_bf16_f32 v78, v10, v11
v_cvt_pk_bf16_f32 v79, v12, v13
v_mfma_f32_32x32x16_bf16 v[240:255], a[28:31], v[72:75], v[240:255]
ds_read_b64_tr_b16 a[24:25], v14 offset:35008
ds_read_b64_tr_b16 a[26:27], v14 offset:39232
s_add_u32 s99, s99, 2048
s_mov_b64 exec, 0xffff
buffer_load_dword a250, v15, s[56:59], s99 offen offset:2048
s_mov_b64 exec, -1
s_waitcnt lgkmcnt(6)
v_mfma_f32_32x32x16_bf16 v[128:143], a[0:3], v[76:79], v[128:143]
ds_read_b64_tr_b16 a[28:29], v14 offset:35040
ds_read_b64_tr_b16 a[30:31], v14 offset:39264
v_lshlrev_b32 v6, 16, v80
v_lshlrev_b32 v8, 16, v81
v_lshlrev_b32 v10, 16, v82
v_lshlrev_b32 v12, 16, v83
v_mfma_f32_32x32x16_bf16 v[144:159], a[4:7], v[76:79], v[144:159]
s_waitcnt vmcnt(21)
s_barrier
ds_read_b64_tr_b16 a[0:1], v3 offset:0
ds_read_b64_tr_b16 a[2:3], v3 offset:4224
v_and_b32 v7, s88, v80
v_and_b32 v9, s88, v81
v_and_b32 v11, s88, v82
v_and_b32 v13, s88, v83
v_mfma_f32_32x32x16_bf16 v[160:175], a[8:11], v[76:79], v[160:175]
ds_read_b64_tr_b16 a[4:5], v3 offset:32
ds_read_b64_tr_b16 a[6:7], v3 offset:4256
s_add_u32 s7, s83, 1395648
buffer_load_dwordx4 v2, s[48:51], s7 offen offset:2112 lds
v_mfma_f32_32x32x16_bf16 v[176:191], a[12:15], v[76:79], v[176:191]
ds_read_b64_tr_b16 a[8:9], v3 offset:64
ds_read_b64_tr_b16 a[10:11], v3 offset:4288
v_add_f32 v6, v6, v4
v_add_f32 v8, v8, v4
v_add_f32 v10, v10, v4
v_add_f32_e64 v12, v12, v4
s_waitcnt lgkmcnt(6)
v_mfma_f32_32x32x16_bf16 v[192:207], a[16:19], v[76:79], v[192:207]
ds_read_b64_tr_b16 a[12:13], v3 offset:96
ds_read_b64_tr_b16 a[14:15], v3 offset:4320
v_add_f32 v7, v7, v4
v_add_f32 v9, v9, v4
v_add_f32 v11, v11, v4
v_add_f32 v13, v13, v4
v_mfma_f32_32x32x16_bf16 v[208:223], a[20:23], v[76:79], v[208:223]
ds_read_b64_tr_b16 a[16:17], v3 offset:128
ds_read_b64_tr_b16 a[18:19], v3 offset:4352
s_add_u32 s7, s83, 1398176
buffer_load_dwordx4 v2, s[48:51], s7 offen offset:3168 lds
v_mfma_f32_32x32x16_bf16 v[224:239], a[24:27], v[76:79], v[224:239]
ds_read_b64_tr_b16 a[20:21], v3 offset:160
ds_read_b64_tr_b16 a[22:23], v3 offset:4384
v_cvt_pk_bf16_f32 v80, v6, v7
v_cvt_pk_bf16_f32 v81, v8, v9
v_cvt_pk_bf16_f32 v82, v10, v11
v_cvt_pk_bf16_f32 v83, v12, v13
v_mfma_f32_32x32x16_bf16 v[240:255], a[28:31], v[76:79], v[240:255]
ds_read_b64_tr_b16 a[24:25], v3 offset:192
ds_read_b64_tr_b16 a[26:27], v3 offset:4416
s_add_u32 s99, s99, 2048
s_mov_b64 exec, 0xffff
buffer_load_dword a250, v15, s[56:59], s99 offen offset:2048
s_mov_b64 exec, -1
s_waitcnt lgkmcnt(6)
v_mfma_f32_32x32x16_bf16 v[128:143], a[0:3], v[80:83], v[128:143]
ds_read_b64_tr_b16 a[28:29], v3 offset:224
ds_read_b64_tr_b16 a[30:31], v3 offset:4448
v_lshlrev_b32 v6, 16, v84
v_lshlrev_b32 v8, 16, v85
v_lshlrev_b32 v10, 16, v86
v_lshlrev_b32 v12, 16, v87
v_and_b32_e64 v7, s88, v84
v_mfma_f32_32x32x16_bf16 v[144:159], a[4:7], v[80:83], v[144:159]
ds_read_b64_tr_b16 a[0:1], v3 offset:256
ds_read_b64_tr_b16 a[2:3], v3 offset:4480
v_and_b32 v9, s88, v85
v_and_b32 v11, s88, v86
v_and_b32 v13, s88, v87
v_add_f32 v6, v6, v4
v_mfma_f32_32x32x16_bf16 v[160:175], a[8:11], v[80:83], v[160:175]
ds_read_b64_tr_b16 a[4:5], v3 offset:288
ds_read_b64_tr_b16 a[6:7], v3 offset:4512
v_add_f32 v8, v8, v4
v_add_f32 v10, v10, v4
v_add_f32 v12, v12, v4
v_add_f32 v7, v7, v4
v_mfma_f32_32x32x16_bf16 v[176:191], a[12:15], v[80:83], v[176:191]
ds_read_b64_tr_b16 a[8:9], v3 offset:320
ds_read_b64_tr_b16 a[10:11], v3 offset:4544
s_add_u32 m0, s96, 0
s_add_u32 s98, s97, 0
buffer_load_dwordx4 v1, s[60:63], s98 offen offset:0 lds
s_waitcnt lgkmcnt(6)
v_mfma_f32_32x32x16_bf16 v[192:207], a[16:19], v[80:83], v[192:207]
ds_read_b64_tr_b16 a[12:13], v3 offset:352
ds_read_b64_tr_b16 a[14:15], v3 offset:4576
v_add_f32 v9, v9, v4
v_add_f32 v11, v11, v4
v_add_f32 v13, v13, v4
v_cvt_pk_bf16_f32 v84, v6, v7
v_cvt_pk_bf16_f32 v85, v8, v9
v_mfma_f32_32x32x16_bf16 v[208:223], a[20:23], v[80:83], v[208:223]
ds_read_b64_tr_b16 a[16:17], v3 offset:384
ds_read_b64_tr_b16 a[18:19], v3 offset:4608
v_cvt_pk_bf16_f32 v86, v10, v11
v_cvt_pk_bf16_f32 v87, v12, v13
s_and_b32 s4, s90, 3
s_lshl_b32 s4, s4, 1
v_mfma_f32_32x32x16_bf16 v[224:239], a[24:27], v[80:83], v[224:239]
ds_read_b64_tr_b16 a[20:21], v3 offset:416
ds_read_b64_tr_b16 a[22:23], v3 offset:4640
s_add_u32 s43, s4, s91
s_sub_u32 s4, s43, 7
s_min_u32 s43, s43, s4
v_lshrrev_b32 v16, 3, v0
v_mfma_f32_32x32x16_bf16 v[240:255], a[28:31], v[80:83], v[240:255]
ds_read_b64_tr_b16 a[24:25], v3 offset:448
ds_read_b64_tr_b16 a[26:27], v3 offset:4672
buffer_load_dwordx4 v1, s[60:63], s98 offen offset:1024 lds
s_waitcnt lgkmcnt(6)
v_mfma_f32_32x32x16_bf16 v[128:143], a[0:3], v[84:87], v[128:143]
ds_read_b64_tr_b16 a[28:29], v3 offset:480
ds_read_b64_tr_b16 a[30:31], v3 offset:4704
v_lshlrev_b32 v6, 16, v88
v_lshlrev_b32 v8, 16, v89
v_lshlrev_b32 v10, 16, v90
v_lshlrev_b32 v12, 16, v91
v_and_b32 v7, s88, v88
v_mfma_f32_32x32x16_bf16 v[144:159], a[4:7], v[84:87], v[144:159]
ds_read_b64_tr_b16 a[0:1], v3 offset:512
ds_read_b64_tr_b16 a[2:3], v3 offset:4736
v_and_b32 v9, s88, v89
v_and_b32 v11, s88, v90
v_and_b32 v13, s88, v91
v_add_f32 v6, v6, v4
v_mfma_f32_32x32x16_bf16 v[160:175], a[8:11], v[84:87], v[160:175]
ds_read_b64_tr_b16 a[4:5], v3 offset:544
ds_read_b64_tr_b16 a[6:7], v3 offset:4768
v_add_f32 v8, v8, v4
v_add_f32 v10, v10, v4
v_add_f32 v12, v12, v4
v_add_f32 v7, v7, v4
v_mfma_f32_32x32x16_bf16 v[176:191], a[12:15], v[84:87], v[176:191]
ds_read_b64_tr_b16 a[8:9], v3 offset:576
ds_read_b64_tr_b16 a[10:11], v3 offset:4800
buffer_load_dwordx4 v1, s[60:63], s98 offen offset:2048 lds
s_waitcnt lgkmcnt(6)
v_mfma_f32_32x32x16_bf16 v[192:207], a[16:19], v[84:87], v[192:207]
ds_read_b64_tr_b16 a[12:13], v3 offset:608
ds_read_b64_tr_b16 a[14:15], v3 offset:4832
v_add_f32 v9, v9, v4
v_add_f32 v11, v11, v4
v_add_f32 v13, v13, v4
v_cvt_pk_bf16_f32 v88, v6, v7
v_cvt_pk_bf16_f32 v89, v8, v9
v_mfma_f32_32x32x16_bf16 v[208:223], a[20:23], v[84:87], v[208:223]
ds_read_b64_tr_b16 a[16:17], v3 offset:640
ds_read_b64_tr_b16 a[18:19], v3 offset:4864
v_cvt_pk_bf16_f32 v90, v10, v11
v_cvt_pk_bf16_f32 v91, v12, v13
v_mul_u32_u24 v2, 896, v16
v_bfe_u32 v16, v0, 4, 1
v_mfma_f32_32x32x16_bf16 v[224:239], a[24:27], v[84:87], v[224:239]
ds_read_b64_tr_b16 a[20:21], v3 offset:672
ds_read_b64_tr_b16 a[22:23], v3 offset:4896
v_lshlrev_b32 v16, 2, v16
v_and_b32 v17, 7, v0
v_xor_b32_e64 v16, v16, v17
v_lshl_add_u32 v2, v16, 4, v2
v_mfma_f32_32x32x16_bf16 v[240:255], a[28:31], v[84:87], v[240:255]
ds_read_b64_tr_b16 a[24:25], v3 offset:704
ds_read_b64_tr_b16 a[26:27], v3 offset:4928
buffer_load_dwordx4 v1, s[60:63], s98 offen offset:3072 lds
s_waitcnt lgkmcnt(6)
v_mfma_f32_32x32x16_bf16 v[128:143], a[0:3], v[88:91], v[128:143]
ds_read_b64_tr_b16 a[28:29], v3 offset:736
ds_read_b64_tr_b16 a[30:31], v3 offset:4960
v_lshlrev_b32 v6, 16, v92
v_lshlrev_b32 v8, 16, v93
v_lshlrev_b32 v10, 16, v94
v_lshlrev_b32 v12, 16, v95
v_and_b32 v7, s88, v92
v_mfma_f32_32x32x16_bf16 v[144:159], a[4:7], v[88:91], v[144:159]
ds_read_b64_tr_b16 a[0:1], v3 offset:768
ds_read_b64_tr_b16 a[2:3], v3 offset:4992
v_and_b32 v9, s88, v93
v_and_b32 v11, s88, v94
v_and_b32 v13, s88, v95
v_add_f32 v6, v6, v4
v_mfma_f32_32x32x16_bf16 v[160:175], a[8:11], v[88:91], v[160:175]
ds_read_b64_tr_b16 a[4:5], v3 offset:800
ds_read_b64_tr_b16 a[6:7], v3 offset:5024
v_add_f32 v8, v8, v4
v_add_f32 v10, v10, v4
v_add_f32 v12, v12, v4
v_add_f32 v7, v7, v4
v_mfma_f32_32x32x16_bf16 v[176:191], a[12:15], v[88:91], v[176:191]
ds_read_b64_tr_b16 a[8:9], v3 offset:832
ds_read_b64_tr_b16 a[10:11], v3 offset:5056
s_add_u32 m0, s96, 4160
s_add_u32 s98, s97, 2
buffer_load_dwordx4 v1, s[60:63], s98 offen offset:0 lds
s_waitcnt lgkmcnt(6)
v_mfma_f32_32x32x16_bf16 v[192:207], a[16:19], v[88:91], v[192:207]
ds_read_b64_tr_b16 a[12:13], v3 offset:864
ds_read_b64_tr_b16 a[14:15], v3 offset:5088
v_add_f32 v9, v9, v4
v_add_f32 v11, v11, v4
v_add_f32_e64 v13, v13, v4
v_cvt_pk_bf16_f32 v92, v6, v7
v_cvt_pk_bf16_f32 v93, v8, v9
v_mfma_f32_32x32x16_bf16 v[208:223], a[20:23], v[88:91], v[208:223]
ds_read_b64_tr_b16 a[16:17], v3 offset:896
ds_read_b64_tr_b16 a[18:19], v3 offset:5120
v_cvt_pk_bf16_f32 v94, v10, v11
v_cvt_pk_bf16_f32 v95, v12, v13
s_mul_i32 s92, s80, 401408
s_lshl_b32 s4, s91, 7
v_mfma_f32_32x32x16_bf16 v[224:239], a[24:27], v[88:91], v[224:239]
ds_read_b64_tr_b16 a[20:21], v3 offset:928
ds_read_b64_tr_b16 a[22:23], v3 offset:5152
s_add_u32 s92, s92, s4
s_sub_u32 s92, s92, 4096
s_lshl_b32 s93, s80, 13
s_lshl_b32 s42, s80, 12
v_mfma_f32_32x32x16_bf16 v[240:255], a[28:31], v[88:91], v[240:255]
ds_read_b64_tr_b16 a[24:25], v3 offset:960
ds_read_b64_tr_b16 a[26:27], v3 offset:5184
buffer_load_dwordx4 v1, s[60:63], s98 offen offset:1024 lds
s_waitcnt lgkmcnt(6)
v_mfma_f32_32x32x16_bf16 v[128:143], a[0:3], v[92:95], v[128:143]
ds_read_b64_tr_b16 a[28:29], v3 offset:992
ds_read_b64_tr_b16 a[30:31], v3 offset:5216
v_lshlrev_b32 v6, 16, v96
v_lshlrev_b32 v8, 16, v97
v_lshlrev_b32 v10, 16, v98
v_lshlrev_b32 v12, 16, v99
v_mfma_f32_32x32x16_bf16 v[144:159], a[4:7], v[92:95], v[144:159]
s_waitcnt vmcnt(19)
s_barrier
ds_read_b64_tr_b16 a[0:1], v3 offset:34048
ds_read_b64_tr_b16 a[2:3], v3 offset:38272
v_and_b32 v7, s88, v96
v_and_b32 v9, s88, v97
v_and_b32 v11, s88, v98
v_mfma_f32_32x32x16_bf16 v[160:175], a[8:11], v[92:95], v[160:175]
ds_read_b64_tr_b16 a[4:5], v3 offset:34080
ds_read_b64_tr_b16 a[6:7], v3 offset:38304
v_and_b32 v13, s88, v99
v_add_f32 v6, v6, v4
v_add_f32_e64 v8, v8, v4
v_mfma_f32_32x32x16_bf16 v[176:191], a[12:15], v[92:95], v[176:191]
ds_read_b64_tr_b16 a[8:9], v3 offset:34112
ds_read_b64_tr_b16 a[10:11], v3 offset:38336
buffer_load_dwordx4 v1, s[60:63], s98 offen offset:2048 lds
s_waitcnt lgkmcnt(6)
v_mfma_f32_32x32x16_bf16 v[192:207], a[16:19], v[92:95], v[192:207]
ds_read_b64_tr_b16 a[12:13], v3 offset:34144
ds_read_b64_tr_b16 a[14:15], v3 offset:38368
v_add_f32 v10, v10, v4
v_add_f32 v12, v12, v4
v_add_f32 v7, v7, v4
v_add_f32_e64 v9, v9, v4
v_mfma_f32_32x32x16_bf16 v[208:223], a[20:23], v[92:95], v[208:223]
ds_read_b64_tr_b16 a[16:17], v3 offset:34176
ds_read_b64_tr_b16 a[18:19], v3 offset:38400
v_add_f32 v11, v11, v4
v_add_f32 v13, v13, v4
v_cvt_pk_bf16_f32 v96, v6, v7
v_mfma_f32_32x32x16_bf16 v[224:239], a[24:27], v[92:95], v[224:239]
ds_read_b64_tr_b16 a[20:21], v3 offset:34208
ds_read_b64_tr_b16 a[22:23], v3 offset:38432
v_cvt_pk_bf16_f32 v97, v8, v9
v_cvt_pk_bf16_f32 v98, v10, v11
v_cvt_pk_bf16_f32 v99, v12, v13
v_mfma_f32_32x32x16_bf16 v[240:255], a[28:31], v[92:95], v[240:255]
ds_read_b64_tr_b16 a[24:25], v3 offset:34240
ds_read_b64_tr_b16 a[26:27], v3 offset:38464
buffer_load_dwordx4 v1, s[60:63], s98 offen offset:3072 lds
s_waitcnt lgkmcnt(6)
v_mfma_f32_32x32x16_bf16 v[128:143], a[0:3], v[96:99], v[128:143]
ds_read_b64_tr_b16 a[28:29], v3 offset:34272
ds_read_b64_tr_b16 a[30:31], v3 offset:38496
v_lshlrev_b32 v6, 16, v100
v_lshlrev_b32 v8, 16, v101
v_lshlrev_b32 v10, 16, v102
v_lshlrev_b32_e64 v12, 16, v103
v_mfma_f32_32x32x16_bf16 v[144:159], a[4:7], v[96:99], v[144:159]
ds_read_b64_tr_b16 a[0:1], v3 offset:34304
ds_read_b64_tr_b16 a[2:3], v3 offset:38528
v_and_b32 v7, s88, v100
v_and_b32 v9, s88, v101
v_and_b32_e64 v11, s88, v102
v_mfma_f32_32x32x16_bf16 v[160:175], a[8:11], v[96:99], v[160:175]
ds_read_b64_tr_b16 a[4:5], v3 offset:34336
ds_read_b64_tr_b16 a[6:7], v3 offset:38560
v_and_b32 v13, s88, v103
v_add_f32 v6, v6, v4
v_add_f32_e64 v8, v8, v4
v_mfma_f32_32x32x16_bf16 v[176:191], a[12:15], v[96:99], v[176:191]
ds_read_b64_tr_b16 a[8:9], v3 offset:34368
ds_read_b64_tr_b16 a[10:11], v3 offset:38592
s_add_u32 s7, s43, 0
s_sub_u32 s75, s7, 7
s_min_u32 s7, s7, s75
s_mul_i32 s7, s7, 57344
s_add_u32 s75, s7, s92
s_add_u32 m0, s93, 0
s_add_u32 s7, s75, 4096
buffer_load_dwordx4 v2, s[56:59], s7 offen offset:0 lds
s_waitcnt lgkmcnt(6)
v_mfma_f32_32x32x16_bf16 v[192:207], a[16:19], v[96:99], v[192:207]
ds_read_b64_tr_b16 a[12:13], v3 offset:34400
ds_read_b64_tr_b16 a[14:15], v3 offset:38624
v_add_f32 v10, v10, v4
v_add_f32 v12, v12, v4
v_add_f32 v7, v7, v4
v_add_f32 v9, v9, v4
v_mfma_f32_32x32x16_bf16 v[208:223], a[20:23], v[96:99], v[208:223]
ds_read_b64_tr_b16 a[16:17], v3 offset:34432
ds_read_b64_tr_b16 a[18:19], v3 offset:38656
v_add_f32 v11, v11, v4
v_add_f32 v13, v13, v4
v_cvt_pk_bf16_f32 v100, v6, v7
v_mfma_f32_32x32x16_bf16 v[224:239], a[24:27], v[96:99], v[224:239]
ds_read_b64_tr_b16 a[20:21], v3 offset:34464
ds_read_b64_tr_b16 a[22:23], v3 offset:38688
v_cvt_pk_bf16_f32 v101, v8, v9
v_cvt_pk_bf16_f32 v102, v10, v11
v_cvt_pk_bf16_f32 v103, v12, v13
v_mfma_f32_32x32x16_bf16 v[240:255], a[28:31], v[96:99], v[240:255]
ds_read_b64_tr_b16 a[24:25], v3 offset:34496
ds_read_b64_tr_b16 a[26:27], v3 offset:38720
s_add_u32 s7, s75, 10240
buffer_load_dwordx4 v2, s[56:59], s7 offen offset:1024 lds
s_waitcnt lgkmcnt(6)
v_mfma_f32_32x32x16_bf16 v[128:143], a[0:3], v[100:103], v[128:143]
ds_read_b64_tr_b16 a[28:29], v3 offset:34528
ds_read_b64_tr_b16 a[30:31], v3 offset:38752
v_lshlrev_b32 v6, 16, v104
v_lshlrev_b32 v8, 16, v105
v_lshlrev_b32 v10, 16, v106
v_lshlrev_b32_e64 v12, 16, v107
v_mfma_f32_32x32x16_bf16 v[144:159], a[4:7], v[100:103], v[144:159]
ds_read_b64_tr_b16 a[0:1], v3 offset:34560
ds_read_b64_tr_b16 a[2:3], v3 offset:38784
v_and_b32 v7, s88, v104
v_and_b32 v9, s88, v105
v_and_b32_e64 v11, s88, v106
v_mfma_f32_32x32x16_bf16 v[160:175], a[8:11], v[100:103], v[160:175]
ds_read_b64_tr_b16 a[4:5], v3 offset:34592
ds_read_b64_tr_b16 a[6:7], v3 offset:38816
v_and_b32 v13, s88, v107
v_add_f32 v6, v6, v4
v_add_f32_e64 v8, v8, v4
v_mfma_f32_32x32x16_bf16 v[176:191], a[12:15], v[100:103], v[176:191]
ds_read_b64_tr_b16 a[8:9], v3 offset:34624
ds_read_b64_tr_b16 a[10:11], v3 offset:38848
s_add_u32 s7, s75, 16384
buffer_load_dwordx4 v2, s[56:59], s7 offen offset:2048 lds
s_waitcnt lgkmcnt(6)
v_mfma_f32_32x32x16_bf16 v[192:207], a[16:19], v[100:103], v[192:207]
ds_read_b64_tr_b16 a[12:13], v3 offset:34656
ds_read_b64_tr_b16 a[14:15], v3 offset:38880
v_add_f32 v10, v10, v4
v_add_f32 v12, v12, v4
v_add_f32 v7, v7, v4
v_add_f32_e64 v9, v9, v4
v_mfma_f32_32x32x16_bf16 v[208:223], a[20:23], v[100:103], v[208:223]
ds_read_b64_tr_b16 a[16:17], v3 offset:34688
ds_read_b64_tr_b16 a[18:19], v3 offset:38912
v_add_f32 v11, v11, v4
v_add_f32 v13, v13, v4
v_cvt_pk_bf16_f32 v104, v6, v7
v_mfma_f32_32x32x16_bf16 v[224:239], a[24:27], v[100:103], v[224:239]
ds_read_b64_tr_b16 a[20:21], v3 offset:34720
ds_read_b64_tr_b16 a[22:23], v3 offset:38944
v_cvt_pk_bf16_f32 v105, v8, v9
v_cvt_pk_bf16_f32 v106, v10, v11
v_cvt_pk_bf16_f32 v107, v12, v13
v_mfma_f32_32x32x16_bf16 v[240:255], a[28:31], v[100:103], v[240:255]
ds_read_b64_tr_b16 a[24:25], v3 offset:34752
ds_read_b64_tr_b16 a[26:27], v3 offset:38976
s_add_u32 s7, s75, 22528
buffer_load_dwordx4 v2, s[56:59], s7 offen offset:3072 lds
s_waitcnt lgkmcnt(6)
v_mfma_f32_32x32x16_bf16 v[128:143], a[0:3], v[104:107], v[128:143]
ds_read_b64_tr_b16 a[28:29], v3 offset:34784
ds_read_b64_tr_b16 a[30:31], v3 offset:39008
v_lshlrev_b32 v6, 16, v108
v_lshlrev_b32 v8, 16, v109
v_lshlrev_b32 v10, 16, v110
v_lshlrev_b32_e64 v12, 16, v111
v_mfma_f32_32x32x16_bf16 v[144:159], a[4:7], v[104:107], v[144:159]
ds_read_b64_tr_b16 a[0:1], v3 offset:34816
ds_read_b64_tr_b16 a[2:3], v3 offset:39040
v_and_b32 v7, s88, v108
v_and_b32 v9, s88, v109
v_and_b32_e64 v11, s88, v110
v_mfma_f32_32x32x16_bf16 v[160:175], a[8:11], v[104:107], v[160:175]
ds_read_b64_tr_b16 a[4:5], v3 offset:34848
ds_read_b64_tr_b16 a[6:7], v3 offset:39072
v_and_b32 v13, s88, v111
v_add_f32 v6, v6, v4
v_add_f32_e64 v8, v8, v4
v_mfma_f32_32x32x16_bf16 v[176:191], a[12:15], v[104:107], v[176:191]
ds_read_b64_tr_b16 a[8:9], v3 offset:34880
ds_read_b64_tr_b16 a[10:11], v3 offset:39104
s_add_u32 m0, s93, 4096
s_add_u32 s7, s75, 32768
buffer_load_dwordx4 v2, s[56:59], s7 offen offset:0 lds
s_waitcnt lgkmcnt(6)
v_mfma_f32_32x32x16_bf16 v[192:207], a[16:19], v[104:107], v[192:207]
ds_read_b64_tr_b16 a[12:13], v3 offset:34912
ds_read_b64_tr_b16 a[14:15], v3 offset:39136
v_add_f32 v10, v10, v4
v_add_f32 v12, v12, v4
v_add_f32 v7, v7, v4
v_add_f32_e64 v9, v9, v4
v_mfma_f32_32x32x16_bf16 v[208:223], a[20:23], v[104:107], v[208:223]
ds_read_b64_tr_b16 a[16:17], v3 offset:34944
ds_read_b64_tr_b16 a[18:19], v3 offset:39168
v_add_f32 v11, v11, v4
v_add_f32 v13, v13, v4
v_cvt_pk_bf16_f32 v108, v6, v7
v_mfma_f32_32x32x16_bf16 v[224:239], a[24:27], v[104:107], v[224:239]
ds_read_b64_tr_b16 a[20:21], v3 offset:34976
ds_read_b64_tr_b16 a[22:23], v3 offset:39200
v_cvt_pk_bf16_f32 v109, v8, v9
v_cvt_pk_bf16_f32 v110, v10, v11
v_cvt_pk_bf16_f32 v111, v12, v13
v_mfma_f32_32x32x16_bf16 v[240:255], a[28:31], v[104:107], v[240:255]
ds_read_b64_tr_b16 a[24:25], v3 offset:35008
ds_read_b64_tr_b16 a[26:27], v3 offset:39232
s_add_u32 s7, s75, 38912
buffer_load_dwordx4 v2, s[56:59], s7 offen offset:1024 lds
s_waitcnt lgkmcnt(6)
v_mfma_f32_32x32x16_bf16 v[128:143], a[0:3], v[108:111], v[128:143]
ds_read_b64_tr_b16 a[28:29], v3 offset:35040
ds_read_b64_tr_b16 a[30:31], v3 offset:39264
v_lshlrev_b32 v6, 16, v112
v_lshlrev_b32 v8, 16, v113
v_lshlrev_b32 v10, 16, v114
v_lshlrev_b32 v12, 16, v115
v_mfma_f32_32x32x16_bf16 v[144:159], a[4:7], v[108:111], v[144:159]
s_waitcnt vmcnt(15)
s_barrier
ds_read_b64_tr_b16 a[0:1], v14 offset:0
ds_read_b64_tr_b16 a[2:3], v14 offset:4224
v_and_b32 v7, s88, v112
v_and_b32 v9, s88, v113
v_and_b32 v11, s88, v114
v_mfma_f32_32x32x16_bf16 v[160:175], a[8:11], v[108:111], v[160:175]
ds_read_b64_tr_b16 a[4:5], v14 offset:32
ds_read_b64_tr_b16 a[6:7], v14 offset:4256
v_and_b32 v13, s88, v115
v_add_f32 v6, v6, v4
v_add_f32_e64 v8, v8, v4
v_mfma_f32_32x32x16_bf16 v[176:191], a[12:15], v[108:111], v[176:191]
ds_read_b64_tr_b16 a[8:9], v14 offset:64
ds_read_b64_tr_b16 a[10:11], v14 offset:4288
s_add_u32 s7, s75, 45056
buffer_load_dwordx4 v2, s[56:59], s7 offen offset:2048 lds
s_waitcnt lgkmcnt(6)
v_mfma_f32_32x32x16_bf16 v[192:207], a[16:19], v[108:111], v[192:207]
ds_read_b64_tr_b16 a[12:13], v14 offset:96
ds_read_b64_tr_b16 a[14:15], v14 offset:4320
v_add_f32 v10, v10, v4
v_add_f32 v12, v12, v4
v_add_f32 v7, v7, v4
v_add_f32_e64 v9, v9, v4
v_mfma_f32_32x32x16_bf16 v[208:223], a[20:23], v[108:111], v[208:223]
ds_read_b64_tr_b16 a[16:17], v14 offset:128
ds_read_b64_tr_b16 a[18:19], v14 offset:4352
v_add_f32 v11, v11, v4
v_add_f32 v13, v13, v4
v_cvt_pk_bf16_f32 v112, v6, v7
v_mfma_f32_32x32x16_bf16 v[224:239], a[24:27], v[108:111], v[224:239]
ds_read_b64_tr_b16 a[20:21], v14 offset:160
ds_read_b64_tr_b16 a[22:23], v14 offset:4384
v_cvt_pk_bf16_f32 v113, v8, v9
v_cvt_pk_bf16_f32 v114, v10, v11
v_cvt_pk_bf16_f32 v115, v12, v13
v_mfma_f32_32x32x16_bf16 v[240:255], a[28:31], v[108:111], v[240:255]
ds_read_b64_tr_b16 a[24:25], v14 offset:192
ds_read_b64_tr_b16 a[26:27], v14 offset:4416
s_add_u32 s7, s75, 51200
buffer_load_dwordx4 v2, s[56:59], s7 offen offset:3072 lds
s_waitcnt lgkmcnt(6)
v_mfma_f32_32x32x16_bf16 v[128:143], a[0:3], v[112:115], v[128:143]
ds_read_b64_tr_b16 a[28:29], v14 offset:224
ds_read_b64_tr_b16 a[30:31], v14 offset:4448
v_lshlrev_b32 v6, 16, v116
v_lshlrev_b32 v8, 16, v117
v_lshlrev_b32 v10, 16, v118
v_lshlrev_b32_e64 v12, 16, v119
v_mfma_f32_32x32x16_bf16 v[144:159], a[4:7], v[112:115], v[144:159]
ds_read_b64_tr_b16 a[0:1], v14 offset:256
ds_read_b64_tr_b16 a[2:3], v14 offset:4480
v_and_b32 v7, s88, v116
v_and_b32 v9, s88, v117
v_and_b32 v11, s88, v118
v_and_b32 v13, s88, v119
v_mfma_f32_32x32x16_bf16 v[160:175], a[8:11], v[112:115], v[160:175]
ds_read_b64_tr_b16 a[4:5], v14 offset:288
ds_read_b64_tr_b16 a[6:7], v14 offset:4512
s_add_u32 s7, s43, 1
s_sub_u32 s75, s7, 7
s_min_u32 s7, s7, s75
s_mul_i32 s7, s7, 57344
s_add_u32 s75, s7, s92
s_add_u32 m0, s93, 34048
s_add_u32 s7, s75, 4096
buffer_load_dwordx4 v2, s[56:59], s7 offen offset:0 lds
v_mfma_f32_32x32x16_bf16 v[176:191], a[12:15], v[112:115], v[176:191]
ds_read_b64_tr_b16 a[8:9], v14 offset:320
ds_read_b64_tr_b16 a[10:11], v14 offset:4544
v_add_f32 v6, v6, v4
v_add_f32 v8, v8, v4
v_add_f32 v10, v10, v4
v_add_f32_e64 v12, v12, v4
s_waitcnt lgkmcnt(6)
v_mfma_f32_32x32x16_bf16 v[192:207], a[16:19], v[112:115], v[192:207]
ds_read_b64_tr_b16 a[12:13], v14 offset:352
ds_read_b64_tr_b16 a[14:15], v14 offset:4576
v_add_f32 v7, v7, v4
v_add_f32 v9, v9, v4
v_add_f32 v11, v11, v4
v_add_f32 v13, v13, v4
v_mfma_f32_32x32x16_bf16 v[208:223], a[20:23], v[112:115], v[208:223]
ds_read_b64_tr_b16 a[16:17], v14 offset:384
ds_read_b64_tr_b16 a[18:19], v14 offset:4608
s_add_u32 s7, s75, 10240
buffer_load_dwordx4 v2, s[56:59], s7 offen offset:1024 lds
v_mfma_f32_32x32x16_bf16 v[224:239], a[24:27], v[112:115], v[224:239]
ds_read_b64_tr_b16 a[20:21], v14 offset:416
ds_read_b64_tr_b16 a[22:23], v14 offset:4640
v_cvt_pk_bf16_f32 v116, v6, v7
v_cvt_pk_bf16_f32 v117, v8, v9
v_cvt_pk_bf16_f32 v118, v10, v11
v_cvt_pk_bf16_f32 v119, v12, v13
v_mfma_f32_32x32x16_bf16 v[240:255], a[28:31], v[112:115], v[240:255]
ds_read_b64_tr_b16 a[24:25], v14 offset:448
ds_read_b64_tr_b16 a[26:27], v14 offset:4672
s_mov_b64 exec, 1
global_load_dword a40, v15, s[38:39] sc1
s_mov_b64 exec, -1
s_waitcnt lgkmcnt(6)
v_mfma_f32_32x32x16_bf16 v[128:143], a[0:3], v[116:119], v[128:143]
ds_read_b64_tr_b16 a[28:29], v14 offset:480
ds_read_b64_tr_b16 a[30:31], v14 offset:4704
v_lshlrev_b32 v6, 16, v120
v_lshlrev_b32 v8, 16, v121
v_lshlrev_b32 v10, 16, v122
v_lshlrev_b32_e64 v12, 16, v123
v_mfma_f32_32x32x16_bf16 v[144:159], a[4:7], v[116:119], v[144:159]
ds_read_b64_tr_b16 a[0:1], v14 offset:512
ds_read_b64_tr_b16 a[2:3], v14 offset:4736
v_and_b32 v7, s88, v120
v_and_b32 v9, s88, v121
v_and_b32_e64 v11, s88, v122
v_mfma_f32_32x32x16_bf16 v[160:175], a[8:11], v[116:119], v[160:175]
ds_read_b64_tr_b16 a[4:5], v14 offset:544
ds_read_b64_tr_b16 a[6:7], v14 offset:4768
v_and_b32 v13, s88, v123
v_add_f32 v6, v6, v4
v_add_f32_e64 v8, v8, v4
v_mfma_f32_32x32x16_bf16 v[176:191], a[12:15], v[116:119], v[176:191]
ds_read_b64_tr_b16 a[8:9], v14 offset:576
ds_read_b64_tr_b16 a[10:11], v14 offset:4800
s_add_u32 s7, s75, 16384
buffer_load_dwordx4 v2, s[56:59], s7 offen offset:2048 lds
s_waitcnt lgkmcnt(6)
v_mfma_f32_32x32x16_bf16 v[192:207], a[16:19], v[116:119], v[192:207]
ds_read_b64_tr_b16 a[12:13], v14 offset:608
ds_read_b64_tr_b16 a[14:15], v14 offset:4832
v_add_f32 v10, v10, v4
v_add_f32 v12, v12, v4
v_add_f32 v7, v7, v4
v_add_f32_e64 v9, v9, v4
v_mfma_f32_32x32x16_bf16 v[208:223], a[20:23], v[116:119], v[208:223]
ds_read_b64_tr_b16 a[16:17], v14 offset:640
ds_read_b64_tr_b16 a[18:19], v14 offset:4864
v_add_f32 v11, v11, v4
v_add_f32 v13, v13, v4
v_cvt_pk_bf16_f32 v120, v6, v7
v_mfma_f32_32x32x16_bf16 v[224:239], a[24:27], v[116:119], v[224:239]
ds_read_b64_tr_b16 a[20:21], v14 offset:672
ds_read_b64_tr_b16 a[22:23], v14 offset:4896
v_cvt_pk_bf16_f32 v121, v8, v9
v_cvt_pk_bf16_f32 v122, v10, v11
v_cvt_pk_bf16_f32 v123, v12, v13
v_mfma_f32_32x32x16_bf16 v[240:255], a[28:31], v[116:119], v[240:255]
ds_read_b64_tr_b16 a[24:25], v14 offset:704
ds_read_b64_tr_b16 a[26:27], v14 offset:4928
s_add_u32 s7, s75, 22528
buffer_load_dwordx4 v2, s[56:59], s7 offen offset:3072 lds
s_waitcnt lgkmcnt(6)
v_mfma_f32_32x32x16_bf16 v[128:143], a[0:3], v[120:123], v[128:143]
ds_read_b64_tr_b16 a[28:29], v14 offset:736
ds_read_b64_tr_b16 a[30:31], v14 offset:4960
v_lshlrev_b32 v6, 16, v124
v_lshlrev_b32 v8, 16, v125
v_lshlrev_b32 v10, 16, v126
v_lshlrev_b32_e64 v12, 16, v127
v_mfma_f32_32x32x16_bf16 v[144:159], a[4:7], v[120:123], v[144:159]
ds_read_b64_tr_b16 a[0:1], v14 offset:768
ds_read_b64_tr_b16 a[2:3], v14 offset:4992
v_and_b32 v7, s88, v124
v_and_b32 v9, s88, v125
v_and_b32_e64 v11, s88, v126
v_mfma_f32_32x32x16_bf16 v[160:175], a[8:11], v[120:123], v[160:175]
ds_read_b64_tr_b16 a[4:5], v14 offset:800
ds_read_b64_tr_b16 a[6:7], v14 offset:5024
v_and_b32 v13, s88, v127
v_add_f32 v6, v6, v4
v_add_f32_e64 v8, v8, v4
v_mfma_f32_32x32x16_bf16 v[176:191], a[12:15], v[120:123], v[176:191]
ds_read_b64_tr_b16 a[8:9], v14 offset:832
ds_read_b64_tr_b16 a[10:11], v14 offset:5056
s_add_u32 m0, s93, 38144
s_add_u32 s7, s75, 32768
buffer_load_dwordx4 v2, s[56:59], s7 offen offset:0 lds
s_waitcnt lgkmcnt(6)
v_mfma_f32_32x32x16_bf16 v[192:207], a[16:19], v[120:123], v[192:207]
ds_read_b64_tr_b16 a[12:13], v14 offset:864
ds_read_b64_tr_b16 a[14:15], v14 offset:5088
v_add_f32 v10, v10, v4
v_add_f32 v12, v12, v4
v_add_f32 v7, v7, v4
v_add_f32_e64 v9, v9, v4
v_mfma_f32_32x32x16_bf16 v[208:223], a[20:23], v[120:123], v[208:223]
ds_read_b64_tr_b16 a[16:17], v14 offset:896
ds_read_b64_tr_b16 a[18:19], v14 offset:5120
v_add_f32 v11, v11, v4
v_add_f32 v13, v13, v4
v_cvt_pk_bf16_f32 v124, v6, v7
v_mfma_f32_32x32x16_bf16 v[224:239], a[24:27], v[120:123], v[224:239]
ds_read_b64_tr_b16 a[20:21], v14 offset:928
ds_read_b64_tr_b16 a[22:23], v14 offset:5152
v_cvt_pk_bf16_f32 v125, v8, v9
v_cvt_pk_bf16_f32 v126, v10, v11
v_cvt_pk_bf16_f32 v127, v12, v13
v_mfma_f32_32x32x16_bf16 v[240:255], a[28:31], v[120:123], v[240:255]
ds_read_b64_tr_b16 a[24:25], v14 offset:960
ds_read_b64_tr_b16 a[26:27], v14 offset:5184
s_add_u32 s7, s75, 38912
buffer_load_dwordx4 v2, s[56:59], s7 offen offset:1024 lds
s_waitcnt lgkmcnt(6)
v_mfma_f32_32x32x16_bf16 v[128:143], a[0:3], v[124:127], v[128:143]
ds_read_b64_tr_b16 a[28:29], v14 offset:992
ds_read_b64_tr_b16 a[30:31], v14 offset:5216
v_lshrrev_b32 v5, 5, v0
v_bfe_u32 v6, v0, 2, 2
v_lshl_add_u32 v5, v5, 2, v6
v_lshlrev_b32_e64 v5, 7, v5
v_bfe_u32 v7, v0, 4, 1
v_lshl_add_u32 v5, v7, 5, v5
v_and_b32_e64 v7, 3, v0
v_lshl_add_u32 v5, v7, 3, v5
v_mfma_f32_32x32x16_bf16 v[144:159], a[4:7], v[124:127], v[144:159]
v_add_u32 v5, s93, v5
v_bfe_u32 v6, v0, 3, 1
v_lshlrev_b32 v6, 6, v6
v_add_u32 v3, v5, v6
v_xor_b32 v6, 64, v6
v_add_u32 v4, v5, v6
v_lshrrev_b32 v10, 4, v0
v_and_b32 v11, 15, v0
v_mfma_f32_32x32x16_bf16 v[160:175], a[8:11], v[124:127], v[160:175]
v_add_u32 v12, v10, v11
v_subrev_u32 v12, 15, v12
v_lshlrev_b32 v12, 1, v12
v_cmp_gt_i32 vcc, 0, v12
v_mov_b32 v13, 0x7fffffff
s_lshl_b32 s5, s94, 12
v_cndmask_b32 v12, v12, v13, vcc
v_mov_b32 v13, 0
v_mfma_f32_32x32x16_bf16 v[176:191], a[12:15], v[124:127], v[176:191]
s_add_u32 s7, s75, 45056
buffer_load_dwordx4 v2, s[56:59], s7 offen offset:2048 lds
s_waitcnt lgkmcnt(0)
v_mfma_f32_32x32x16_bf16 v[192:207], a[16:19], v[124:127], v[192:207]
buffer_load_ushort v12, v12, s[60:63], s5 offen
s_lshl_b32 s5, s94, 1
buffer_load_ushort v15, v13, s[68:71], s5 offen
v_mul_u32_u24 v10, 4160, v10
v_lshl_add_u32 v10, v11, 1, v10
s_lshr_b32 s4, s80, 1
s_mul_i32 s6, s4, 16640
s_add_u32 s6, s6, 118528
v_mfma_f32_32x32x16_bf16 v[208:223], a[20:23], v[124:127], v[208:223]
v_add_u32 v10, s6, v10
s_mul_i32 s6, s4, 4608
s_add_u32 s6, s6, 155904
v_add_u32 v11, s6, v1
v_mov_b32 v20, 0
v_mov_b32 v21, 0
v_mov_b32 v22, 0
v_mov_b32_e64 v23, 0
v_mfma_f32_32x32x16_bf16 v[224:239], a[24:27], v[124:127], v[224:239]
v_accvgpr_read_b32 v16, a144
v_accvgpr_read_b32 v17, a145
v_accvgpr_read_b32 v18, a146
s_lshl_b32 s4, s81, 2
s_add_u32 s4, s4, s80
s_mul_i32 s95, s4, 114688
s_lshl_b32 s5, s82, 13
s_add_u32 s95, s95, s5
v_mfma_f32_32x32x16_bf16 v[240:255], a[28:31], v[124:127], v[240:255]
s_add_u32 s7, s75, 51200
buffer_load_dwordx4 v2, s[56:59], s7 offen offset:3072 lds
s_barrier
s_waitcnt vmcnt(8)
v_accvgpr_read_b32 v8, a40
v_mov_b32_e64 v9, 0
s_nop 0
v_readfirstlane_b32 s6, v8
s_cmp_ge_u32 s6, 1
s_cbranch_scc1 Lok_3
s_mov_b32 s5, 0x40000
Lspin_4:
global_load_dword v8, v9, s[38:39] sc1
s_waitcnt vmcnt(0)
v_readfirstlane_b32 s6, v8
s_sub_u32 s5, s5, 1
s_cmp_ge_u32 s6, 1
s_cbranch_scc1 Lspun_5
s_sleep 1
s_cmp_lg_u32 s5, 0
s_cbranch_scc1 Lspin_4
Lspun_5:
Lok_3:
v_mov_b32 v9, 11029504
global_load_dword v8, v9, s[40:41] sc1
s_mov_b32 exec_hi, 0
ds_write_b128 v11, v[20:23]
s_mov_b32 exec_hi, -1
v_pk_mul_f32 v[24:25], v[128:129], v[128:129]
v_pk_mul_f32 v[26:27], v[130:131], v[130:131]
v_pk_mul_f32 v[28:29], v[132:133], v[132:133]
v_pk_mul_f32 v[30:31], v[134:135], v[134:135]
v_pk_fma_f32 v[24:25], v[24:25], v[16:17], v[16:17] op_sel:[0,1,0] op_sel_hi:[1,1,0]
v_pk_fma_f32 v[26:27], v[26:27], v[16:17], v[16:17] op_sel:[0,1,0] op_sel_hi:[1,1,0]
v_pk_fma_f32 v[28:29], v[28:29], v[16:17], v[16:17] op_sel:[0,1,0] op_sel_hi:[1,1,0]
v_pk_fma_f32 v[30:31], v[30:31], v[16:17], v[16:17] op_sel:[0,1,0] op_sel_hi:[1,1,0]
v_pk_mul_f32 v[24:25], v[24:25], v[128:129]
s_add_u32 s7, s43, 2
s_sub_u32 s75, s7, 7
s_min_u32 s7, s7, s75
s_mul_i32 s7, s7, 57344
s_add_u32 s75, s7, s92
s_add_u32 m0, s93, 68096
s_add_u32 s7, s75, 4096
buffer_load_dwordx4 v2, s[56:59], s7 offen offset:0 lds
v_pk_mul_f32 v[26:27], v[26:27], v[130:131]
v_pk_mul_f32 v[28:29], v[28:29], v[132:133]
v_pk_mul_f32 v[30:31], v[30:31], v[134:135]
v_exp_f32 v24, v24
v_exp_f32 v25, v25
v_exp_f32 v26, v26
v_exp_f32 v27, v27
v_exp_f32 v28, v28
v_exp_f32 v29, v29
v_exp_f32 v30, v30
v_exp_f32 v31, v31
v_pk_mul_f32 v[32:33], v[128:129], v[136:137]
s_add_u32 s7, s75, 10240
buffer_load_dwordx4 v2, s[56:59], s7 offen offset:1024 lds
v_pk_mul_f32 v[34:35], v[130:131], v[138:139]
v_pk_mul_f32 v[36:37], v[132:133], v[140:141]
v_pk_mul_f32 v[38:39], v[134:135], v[142:143]
v_pk_fma_f32 v[24:25], v[24:25], v[18:19], v[18:19] op_sel_hi:[1,0,0]
v_pk_fma_f32 v[26:27], v[26:27], v[18:19], v[18:19] op_sel_hi:[1,0,0]
v_pk_fma_f32 v[28:29], v[28:29], v[18:19], v[18:19] op_sel_hi:[1,0,0]
v_pk_fma_f32 v[30:31], v[30:31], v[18:19], v[18:19] op_sel_hi:[1,0,0]
v_rcp_f32 v24, v24
v_rcp_f32 v25, v25
v_rcp_f32 v26, v26
v_rcp_f32 v27, v27
v_rcp_f32_e64 v28, v28
s_add_u32 s7, s75, 16384
buffer_load_dwordx4 v2, s[56:59], s7 offen offset:2048 lds
v_rcp_f32 v29, v29
v_rcp_f32 v30, v30
v_rcp_f32 v31, v31
s_nop 0
v_pk_mul_f32 v[32:33], v[32:33], v[24:25]
v_pk_mul_f32 v[34:35], v[34:35], v[26:27]
v_pk_mul_f32 v[36:37], v[36:37], v[28:29]
v_pk_mul_f32 v[38:39], v[38:39], v[30:31]
v_cvt_pk_bf16_f32 v40, v32, v33
v_cvt_pk_bf16_f32 v41, v34, v35
s_add_u32 s7, s75, 22528
buffer_load_dwordx4 v2, s[56:59], s7 offen offset:3072 lds
v_cvt_pk_bf16_f32 v42, v36, v37
v_cvt_pk_bf16_f32 v43, v38, v39
buffer_store_dwordx4 v[40:43], v1, s[52:55], s95 offen offset:0 sc1
v_pk_mul_f32 v[48:49], v[144:145], v[144:145]
v_pk_mul_f32 v[50:51], v[146:147], v[146:147]
v_pk_mul_f32 v[52:53], v[148:149], v[148:149]
v_pk_mul_f32 v[54:55], v[150:151], v[150:151]
v_pk_fma_f32 v[48:49], v[48:49], v[16:17], v[16:17] op_sel:[0,1,0] op_sel_hi:[1,1,0]
v_pk_fma_f32 v[50:51], v[50:51], v[16:17], v[16:17] op_sel:[0,1,0] op_sel_hi:[1,1,0]
v_pk_fma_f32 v[52:53], v[52:53], v[16:17], v[16:17] op_sel:[0,1,0] op_sel_hi:[1,1,0]
v_pk_fma_f32 v[54:55], v[54:55], v[16:17], v[16:17] op_sel:[0,1,0] op_sel_hi:[1,1,0]
v_pk_mul_f32 v[48:49], v[48:49], v[144:145]
s_add_u32 m0, s93, 72192
s_add_u32 s7, s75, 32768
buffer_load_dwordx4 v2, s[56:59], s7 offen offset:0 lds
v_pk_mul_f32 v[50:51], v[50:51], v[146:147]
v_pk_mul_f32 v[52:53], v[52:53], v[148:149]
v_pk_mul_f32 v[54:55], v[54:55], v[150:151]
v_exp_f32 v48, v48
v_exp_f32 v49, v49
v_exp_f32 v50, v50
v_exp_f32 v51, v51
v_exp_f32 v52, v52
v_exp_f32 v53, v53
v_exp_f32 v54, v54
v_exp_f32 v55, v55
v_pk_mul_f32 v[56:57], v[144:145], v[152:153]
s_add_u32 s7, s75, 38912
buffer_load_dwordx4 v2, s[56:59], s7 offen offset:1024 lds
v_pk_mul_f32 v[58:59], v[146:147], v[154:155]
v_pk_mul_f32 v[60:61], v[148:149], v[156:157]
v_pk_mul_f32 v[62:63], v[150:151], v[158:159]
v_pk_fma_f32 v[48:49], v[48:49], v[18:19], v[18:19] op_sel_hi:[1,0,0]
v_pk_fma_f32 v[50:51], v[50:51], v[18:19], v[18:19] op_sel_hi:[1,0,0]
v_pk_fma_f32 v[52:53], v[52:53], v[18:19], v[18:19] op_sel_hi:[1,0,0]
v_pk_fma_f32 v[54:55], v[54:55], v[18:19], v[18:19] op_sel_hi:[1,0,0]
v_rcp_f32 v48, v48
v_rcp_f32 v49, v49
v_rcp_f32 v50, v50
v_rcp_f32 v51, v51
v_rcp_f32_e64 v52, v52
s_add_u32 s7, s75, 45056
buffer_load_dwordx4 v2, s[56:59], s7 offen offset:2048 lds
v_rcp_f32 v53, v53
v_rcp_f32 v54, v54
v_rcp_f32 v55, v55
s_nop 0
v_pk_mul_f32 v[56:57], v[56:57], v[48:49]
v_pk_mul_f32 v[58:59], v[58:59], v[50:51]
v_pk_mul_f32 v[60:61], v[60:61], v[52:53]
v_pk_mul_f32 v[62:63], v[62:63], v[54:55]
v_cvt_pk_bf16_f32 v64, v56, v57
v_cvt_pk_bf16_f32 v65, v58, v59
s_add_u32 s7, s75, 51200
buffer_load_dwordx4 v2, s[56:59], s7 offen offset:3072 lds
v_cvt_pk_bf16_f32 v66, v60, v61
v_cvt_pk_bf16_f32 v67, v62, v63
buffer_store_dwordx4 v[64:67], v1, s[52:55], s95 offen offset:1024 sc1
v_pk_mul_f32 v[24:25], v[160:161], v[160:161]
v_pk_mul_f32 v[26:27], v[162:163], v[162:163]
v_pk_mul_f32 v[28:29], v[164:165], v[164:165]
v_pk_mul_f32 v[30:31], v[166:167], v[166:167]
v_pk_fma_f32 v[24:25], v[24:25], v[16:17], v[16:17] op_sel:[0,1,0] op_sel_hi:[1,1,0]
v_pk_fma_f32 v[26:27], v[26:27], v[16:17], v[16:17] op_sel:[0,1,0] op_sel_hi:[1,1,0]
v_pk_fma_f32 v[28:29], v[28:29], v[16:17], v[16:17] op_sel:[0,1,0] op_sel_hi:[1,1,0]
v_pk_fma_f32 v[30:31], v[30:31], v[16:17], v[16:17] op_sel:[0,1,0] op_sel_hi:[1,1,0]
v_pk_mul_f32 v[24:25], v[24:25], v[160:161]
s_add_u32 s7, s43, 3
s_sub_u32 s75, s7, 7
s_min_u32 s7, s7, s75
s_mul_i32 s7, s7, 57344
s_add_u32 s75, s7, s92
s_add_u32 m0, s42, 102144
s_add_u32 s7, s75, 4096
buffer_load_dwordx4 v2, s[56:59], s7 offen offset:0 lds
v_pk_mul_f32 v[26:27], v[26:27], v[162:163]
v_pk_mul_f32 v[28:29], v[28:29], v[164:165]
v_pk_mul_f32 v[30:31], v[30:31], v[166:167]
v_exp_f32 v24, v24
v_exp_f32 v25, v25
v_exp_f32 v26, v26
v_exp_f32 v27, v27
v_exp_f32 v28, v28
v_exp_f32 v29, v29
v_exp_f32 v30, v30
v_exp_f32 v31, v31
v_pk_mul_f32 v[32:33], v[160:161], v[168:169]
s_add_u32 s7, s75, 10240
buffer_load_dwordx4 v2, s[56:59], s7 offen offset:1024 lds
v_pk_mul_f32 v[34:35], v[162:163], v[170:171]
v_pk_mul_f32 v[36:37], v[164:165], v[172:173]
v_pk_mul_f32 v[38:39], v[166:167], v[174:175]
v_pk_fma_f32 v[24:25], v[24:25], v[18:19], v[18:19] op_sel_hi:[1,0,0]
v_pk_fma_f32 v[26:27], v[26:27], v[18:19], v[18:19] op_sel_hi:[1,0,0]
v_pk_fma_f32 v[28:29], v[28:29], v[18:19], v[18:19] op_sel_hi:[1,0,0]
v_pk_fma_f32 v[30:31], v[30:31], v[18:19], v[18:19] op_sel_hi:[1,0,0]
v_rcp_f32 v24, v24
v_rcp_f32 v25, v25
v_rcp_f32 v26, v26
v_rcp_f32 v27, v27
v_rcp_f32_e64 v28, v28
s_add_u32 s7, s75, 16384
buffer_load_dwordx4 v2, s[56:59], s7 offen offset:2048 lds
v_rcp_f32 v29, v29
v_rcp_f32 v30, v30
v_rcp_f32 v31, v31
s_nop 0
v_pk_mul_f32 v[32:33], v[32:33], v[24:25]
v_pk_mul_f32 v[34:35], v[34:35], v[26:27]
v_pk_mul_f32 v[36:37], v[36:37], v[28:29]
v_pk_mul_f32 v[38:39], v[38:39], v[30:31]
v_cvt_pk_bf16_f32 v40, v32, v33
v_cvt_pk_bf16_f32 v41, v34, v35
s_add_u32 s7, s75, 22528
buffer_load_dwordx4 v2, s[56:59], s7 offen offset:3072 lds
v_cvt_pk_bf16_f32 v42, v36, v37
v_cvt_pk_bf16_f32 v43, v38, v39
buffer_store_dwordx4 v[40:43], v1, s[52:55], s95 offen offset:2048 sc1
v_pk_mul_f32 v[48:49], v[176:177], v[176:177]
v_pk_mul_f32 v[50:51], v[178:179], v[178:179]
v_pk_mul_f32 v[52:53], v[180:181], v[180:181]
v_pk_mul_f32 v[54:55], v[182:183], v[182:183]
v_pk_fma_f32 v[48:49], v[48:49], v[16:17], v[16:17] op_sel:[0,1,0] op_sel_hi:[1,1,0]
v_pk_fma_f32 v[50:51], v[50:51], v[16:17], v[16:17] op_sel:[0,1,0] op_sel_hi:[1,1,0]
v_pk_fma_f32 v[52:53], v[52:53], v[16:17], v[16:17] op_sel:[0,1,0] op_sel_hi:[1,1,0]
v_pk_fma_f32 v[54:55], v[54:55], v[16:17], v[16:17] op_sel:[0,1,0] op_sel_hi:[1,1,0]
v_pk_mul_f32 v[48:49], v[48:49], v[176:177]
v_pk_mul_f32 v[50:51], v[50:51], v[178:179]
v_pk_mul_f32 v[52:53], v[52:53], v[180:181]
v_pk_mul_f32 v[54:55], v[54:55], v[182:183]
v_exp_f32 v48, v48
v_exp_f32 v49, v49
v_exp_f32 v50, v50
v_exp_f32 v51, v51
v_exp_f32 v52, v52
v_exp_f32 v53, v53
v_exp_f32 v54, v54
v_exp_f32 v55, v55
v_pk_mul_f32 v[56:57], v[176:177], v[184:185]
v_pk_mul_f32 v[58:59], v[178:179], v[186:187]
v_pk_mul_f32 v[60:61], v[180:181], v[188:189]
v_pk_mul_f32 v[62:63], v[182:183], v[190:191]
v_pk_fma_f32 v[48:49], v[48:49], v[18:19], v[18:19] op_sel_hi:[1,0,0]
v_pk_fma_f32 v[50:51], v[50:51], v[18:19], v[18:19] op_sel_hi:[1,0,0]
v_pk_fma_f32 v[52:53], v[52:53], v[18:19], v[18:19] op_sel_hi:[1,0,0]
v_pk_fma_f32 v[54:55], v[54:55], v[18:19], v[18:19] op_sel_hi:[1,0,0]
v_rcp_f32 v48, v48
v_rcp_f32 v49, v49
v_rcp_f32 v50, v50
v_rcp_f32 v51, v51
v_rcp_f32 v52, v52
v_rcp_f32 v53, v53
v_rcp_f32 v54, v54
v_rcp_f32_e64 v55, v55
s_nop 0
v_pk_mul_f32 v[56:57], v[56:57], v[48:49]
v_pk_mul_f32 v[58:59], v[58:59], v[50:51]
v_pk_mul_f32 v[60:61], v[60:61], v[52:53]
v_pk_mul_f32 v[62:63], v[62:63], v[54:55]
v_cvt_pk_bf16_f32 v64, v56, v57
v_cvt_pk_bf16_f32 v65, v58, v59
v_cvt_pk_bf16_f32 v66, v60, v61
v_cvt_pk_bf16_f32 v67, v62, v63
buffer_store_dwordx4 v[64:67], v1, s[52:55], s95 offen offset:3072 sc1
s_waitcnt vmcnt(16)
v_readfirstlane_b32 s6, v8
s_cmp_ge_u32 s6, 32
s_cbranch_scc1 Lok_6
s_mov_b32 s5, 0x40000
Lspin_7:
global_load_dword v8, v9, s[40:41] sc1
s_waitcnt vmcnt(0)
v_readfirstlane_b32 s6, v8
s_sub_u32 s5, s5, 1
s_cmp_ge_u32 s6, 32
s_cbranch_scc1 Lspun_8
s_sleep 1
s_cmp_lg_u32 s5, 0
s_cbranch_scc1 Lspin_7
Lspun_8:
Lok_6:
s_lshr_b32 s4, s80, 1
s_and_b32 s5, s80, 1
s_lshl_b32 s5, s5, 11
s_mul_i32 s6, s4, 4608
s_add_u32 s6, s6, s5
s_add_u32 m0, s6, 151808
s_lshl_b32 s7, s94, 12
s_add_u32 s7, s7, s5
s_add_u32 s7, s7, 7340032
buffer_load_dwordx4 v1, s[52:55], s7 offen sc1 lds
buffer_load_dwordx4 v1, s[52:55], s7 offen offset:1024 sc1 lds
ds_write_b16 v10, v12
v_pk_mul_f32 v[24:25], v[192:193], v[192:193]
v_pk_mul_f32 v[26:27], v[194:195], v[194:195]
v_pk_mul_f32 v[28:29], v[196:197], v[196:197]
v_pk_mul_f32 v[30:31], v[198:199], v[198:199]
v_pk_fma_f32 v[24:25], v[24:25], v[16:17], v[16:17] op_sel:[0,1,0] op_sel_hi:[1,1,0]
v_pk_fma_f32 v[26:27], v[26:27], v[16:17], v[16:17] op_sel:[0,1,0] op_sel_hi:[1,1,0]
v_pk_fma_f32 v[28:29], v[28:29], v[16:17], v[16:17] op_sel:[0,1,0] op_sel_hi:[1,1,0]
v_pk_fma_f32 v[30:31], v[30:31], v[16:17], v[16:17] op_sel:[0,1,0] op_sel_hi:[1,1,0]
v_pk_mul_f32 v[24:25], v[24:25], v[192:193]
v_pk_mul_f32 v[26:27], v[26:27], v[194:195]
v_pk_mul_f32 v[28:29], v[28:29], v[196:197]
v_pk_mul_f32 v[30:31], v[30:31], v[198:199]
v_exp_f32 v24, v24
v_exp_f32 v25, v25
v_exp_f32 v26, v26
v_exp_f32 v27, v27
v_exp_f32 v28, v28
v_exp_f32 v29, v29
v_exp_f32 v30, v30
v_exp_f32 v31, v31
v_pk_mul_f32 v[32:33], v[192:193], v[200:201]
v_pk_mul_f32 v[34:35], v[194:195], v[202:203]
v_pk_mul_f32 v[36:37], v[196:197], v[204:205]
v_pk_mul_f32 v[38:39], v[198:199], v[206:207]
v_pk_fma_f32 v[24:25], v[24:25], v[18:19], v[18:19] op_sel_hi:[1,0,0]
v_pk_fma_f32 v[26:27], v[26:27], v[18:19], v[18:19] op_sel_hi:[1,0,0]
v_pk_fma_f32 v[28:29], v[28:29], v[18:19], v[18:19] op_sel_hi:[1,0,0]
v_pk_fma_f32 v[30:31], v[30:31], v[18:19], v[18:19] op_sel_hi:[1,0,0]
v_rcp_f32 v24, v24
v_rcp_f32 v25, v25
v_rcp_f32 v26, v26
v_rcp_f32 v27, v27
v_rcp_f32 v28, v28
v_rcp_f32 v29, v29
v_rcp_f32 v30, v30
v_rcp_f32_e64 v31, v31
s_nop 0
v_pk_mul_f32 v[32:33], v[32:33], v[24:25]
v_pk_mul_f32 v[34:35], v[34:35], v[26:27]
v_pk_mul_f32 v[36:37], v[36:37], v[28:29]
v_pk_mul_f32 v[38:39], v[38:39], v[30:31]
v_cvt_pk_bf16_f32 v40, v32, v33
v_cvt_pk_bf16_f32 v41, v34, v35
v_cvt_pk_bf16_f32 v42, v36, v37
v_cvt_pk_bf16_f32 v43, v38, v39
s_add_u32 s95, s95, 4096
buffer_store_dwordx4 v[40:43], v1, s[52:55], s95 offen offset:0 sc1
v_pk_mul_f32 v[48:49], v[208:209], v[208:209]
v_pk_mul_f32 v[50:51], v[210:211], v[210:211]
v_pk_mul_f32 v[52:53], v[212:213], v[212:213]
v_pk_mul_f32 v[54:55], v[214:215], v[214:215]
v_pk_fma_f32 v[48:49], v[48:49], v[16:17], v[16:17] op_sel:[0,1,0] op_sel_hi:[1,1,0]
v_pk_fma_f32 v[50:51], v[50:51], v[16:17], v[16:17] op_sel:[0,1,0] op_sel_hi:[1,1,0]
v_pk_fma_f32 v[52:53], v[52:53], v[16:17], v[16:17] op_sel:[0,1,0] op_sel_hi:[1,1,0]
v_pk_fma_f32 v[54:55], v[54:55], v[16:17], v[16:17] op_sel:[0,1,0] op_sel_hi:[1,1,0]
v_pk_mul_f32 v[48:49], v[48:49], v[208:209]
v_pk_mul_f32 v[50:51], v[50:51], v[210:211]
v_pk_mul_f32 v[52:53], v[52:53], v[212:213]
v_pk_mul_f32 v[54:55], v[54:55], v[214:215]
v_exp_f32 v48, v48
v_exp_f32 v49, v49
v_exp_f32 v50, v50
v_exp_f32 v51, v51
v_exp_f32 v52, v52
v_exp_f32 v53, v53
v_exp_f32 v54, v54
v_exp_f32 v55, v55
v_pk_mul_f32 v[56:57], v[208:209], v[216:217]
v_pk_mul_f32 v[58:59], v[210:211], v[218:219]
v_pk_mul_f32 v[60:61], v[212:213], v[220:221]
v_pk_mul_f32 v[62:63], v[214:215], v[222:223]
v_pk_fma_f32 v[48:49], v[48:49], v[18:19], v[18:19] op_sel_hi:[1,0,0]
v_pk_fma_f32 v[50:51], v[50:51], v[18:19], v[18:19] op_sel_hi:[1,0,0]
v_pk_fma_f32 v[52:53], v[52:53], v[18:19], v[18:19] op_sel_hi:[1,0,0]
v_pk_fma_f32 v[54:55], v[54:55], v[18:19], v[18:19] op_sel_hi:[1,0,0]
v_rcp_f32 v48, v48
v_rcp_f32 v49, v49
v_rcp_f32 v50, v50
v_rcp_f32 v51, v51
v_rcp_f32 v52, v52
v_rcp_f32 v53, v53
v_rcp_f32 v54, v54
v_rcp_f32_e64 v55, v55
s_nop 0
v_pk_mul_f32 v[56:57], v[56:57], v[48:49]
v_pk_mul_f32 v[58:59], v[58:59], v[50:51]
v_pk_mul_f32 v[60:61], v[60:61], v[52:53]
v_pk_mul_f32 v[62:63], v[62:63], v[54:55]
v_cvt_pk_bf16_f32 v64, v56, v57
v_cvt_pk_bf16_f32 v65, v58, v59
v_cvt_pk_bf16_f32 v66, v60, v61
v_cvt_pk_bf16_f32 v67, v62, v63
buffer_store_dwordx4 v[64:67], v1, s[52:55], s95 offen offset:1024 sc1
v_pk_mul_f32 v[24:25], v[224:225], v[224:225]
v_pk_mul_f32 v[26:27], v[226:227], v[226:227]
v_pk_mul_f32 v[28:29], v[228:229], v[228:229]
v_pk_mul_f32 v[30:31], v[230:231], v[230:231]
v_pk_fma_f32 v[24:25], v[24:25], v[16:17], v[16:17] op_sel:[0,1,0] op_sel_hi:[1,1,0]
v_pk_fma_f32 v[26:27], v[26:27], v[16:17], v[16:17] op_sel:[0,1,0] op_sel_hi:[1,1,0]
v_pk_fma_f32 v[28:29], v[28:29], v[16:17], v[16:17] op_sel:[0,1,0] op_sel_hi:[1,1,0]
v_pk_fma_f32 v[30:31], v[30:31], v[16:17], v[16:17] op_sel:[0,1,0] op_sel_hi:[1,1,0]
v_pk_mul_f32 v[24:25], v[24:25], v[224:225]
v_pk_mul_f32 v[26:27], v[26:27], v[226:227]
v_pk_mul_f32 v[28:29], v[28:29], v[228:229]
v_pk_mul_f32 v[30:31], v[30:31], v[230:231]
v_exp_f32 v24, v24
v_exp_f32 v25, v25
v_exp_f32 v26, v26
v_exp_f32 v27, v27
v_exp_f32 v28, v28
v_exp_f32 v29, v29
v_exp_f32 v30, v30
v_exp_f32 v31, v31
v_pk_mul_f32 v[32:33], v[224:225], v[232:233]
v_pk_mul_f32 v[34:35], v[226:227], v[234:235]
v_pk_mul_f32 v[36:37], v[228:229], v[236:237]
v_pk_mul_f32 v[38:39], v[230:231], v[238:239]
v_pk_fma_f32 v[24:25], v[24:25], v[18:19], v[18:19] op_sel_hi:[1,0,0]
v_pk_fma_f32 v[26:27], v[26:27], v[18:19], v[18:19] op_sel_hi:[1,0,0]
v_pk_fma_f32 v[28:29], v[28:29], v[18:19], v[18:19] op_sel_hi:[1,0,0]
v_pk_fma_f32 v[30:31], v[30:31], v[18:19], v[18:19] op_sel_hi:[1,0,0]
v_rcp_f32 v24, v24
v_rcp_f32 v25, v25
v_rcp_f32 v26, v26
v_rcp_f32 v27, v27
v_rcp_f32 v28, v28
v_rcp_f32 v29, v29
v_rcp_f32 v30, v30
v_rcp_f32_e64 v31, v31
s_nop 0
v_pk_mul_f32 v[32:33], v[32:33], v[24:25]
v_pk_mul_f32 v[34:35], v[34:35], v[26:27]
v_pk_mul_f32 v[36:37], v[36:37], v[28:29]
v_pk_mul_f32 v[38:39], v[38:39], v[30:31]
v_cvt_pk_bf16_f32 v40, v32, v33
v_cvt_pk_bf16_f32 v41, v34, v35
v_cvt_pk_bf16_f32 v42, v36, v37
v_cvt_pk_bf16_f32 v43, v38, v39
buffer_store_dwordx4 v[40:43], v1, s[52:55], s95 offen offset:2048 sc1
v_pk_mul_f32 v[48:49], v[240:241], v[240:241]
v_pk_mul_f32 v[50:51], v[242:243], v[242:243]
v_pk_mul_f32 v[52:53], v[244:245], v[244:245]
v_pk_mul_f32 v[54:55], v[246:247], v[246:247]
v_pk_fma_f32 v[48:49], v[48:49], v[16:17], v[16:17] op_sel:[0,1,0] op_sel_hi:[1,1,0]
v_pk_fma_f32 v[50:51], v[50:51], v[16:17], v[16:17] op_sel:[0,1,0] op_sel_hi:[1,1,0]
v_pk_fma_f32 v[52:53], v[52:53], v[16:17], v[16:17] op_sel:[0,1,0] op_sel_hi:[1,1,0]
v_pk_fma_f32 v[54:55], v[54:55], v[16:17], v[16:17] op_sel:[0,1,0] op_sel_hi:[1,1,0]
v_pk_mul_f32 v[48:49], v[48:49], v[240:241]
v_pk_mul_f32 v[50:51], v[50:51], v[242:243]
v_pk_mul_f32 v[52:53], v[52:53], v[244:245]
v_pk_mul_f32 v[54:55], v[54:55], v[246:247]
v_exp_f32 v48, v48
v_exp_f32 v49, v49
v_exp_f32 v50, v50
v_exp_f32 v51, v51
v_exp_f32 v52, v52
v_exp_f32 v53, v53
v_exp_f32 v54, v54
v_exp_f32 v55, v55
v_pk_mul_f32 v[56:57], v[240:241], v[248:249]
v_pk_mul_f32 v[58:59], v[242:243], v[250:251]
v_pk_mul_f32 v[60:61], v[244:245], v[252:253]
v_pk_mul_f32 v[62:63], v[246:247], v[254:255]
v_pk_fma_f32 v[48:49], v[48:49], v[18:19], v[18:19] op_sel_hi:[1,0,0]
v_pk_fma_f32 v[50:51], v[50:51], v[18:19], v[18:19] op_sel_hi:[1,0,0]
v_pk_fma_f32 v[52:53], v[52:53], v[18:19], v[18:19] op_sel_hi:[1,0,0]
v_pk_fma_f32 v[54:55], v[54:55], v[18:19], v[18:19] op_sel_hi:[1,0,0]
v_rcp_f32 v48, v48
v_rcp_f32 v49, v49
v_rcp_f32 v50, v50
v_rcp_f32 v51, v51
v_rcp_f32 v52, v52
v_rcp_f32 v53, v53
v_rcp_f32 v54, v54
v_rcp_f32_e64 v55, v55
s_nop 0
v_pk_mul_f32 v[56:57], v[56:57], v[48:49]
v_pk_mul_f32 v[58:59], v[58:59], v[50:51]
v_pk_mul_f32 v[60:61], v[60:61], v[52:53]
v_pk_mul_f32 v[62:63], v[62:63], v[54:55]
v_cvt_pk_bf16_f32 v64, v56, v57
v_cvt_pk_bf16_f32 v65, v58, v59
v_cvt_pk_bf16_f32 v66, v60, v61
v_cvt_pk_bf16_f32 v67, v62, v63
buffer_store_dwordx4 v[64:67], v1, s[52:55], s95 offen offset:3072 sc1
s_waitcnt vmcnt(4) lgkmcnt(0)
s_barrier
v_lshlrev_b32 v8, 16, v15
s_lshr_b32 s4, s80, 1
s_mul_i32 s6, s4, 16640
s_add_u32 s6, s6, 118528
v_bfe_u32 v5, v0, 2, 2
v_mul_u32_u24 v14, 4160, v5
v_and_b32 v6, 3, v0
v_lshl_add_u32 v14, v6, 3, v14
v_lshrrev_b32 v6, 4, v0
v_lshl_add_u32 v14, v6, 4, v14
s_and_b32 s5, s80, 1
s_lshl_b32 s5, s5, 8
s_add_u32 s6, s6, s5
v_add_u32 v14, s6, v14
v_and_b32 v7, 15, v0
v_lshlrev_b32 v7, 5, v7
v_lshlrev_b32 v5, 4, v6
v_sub_u32 v15, v5, v7
s_mul_i32 s6, s4, 4608
s_add_u32 s6, s6, 152288
s_add_u32 s7, s6, s5
v_add_u32 v15, s7, v15
ds_read_b128 v[108:111], v15 offset:0
ds_read_b64_tr_b16 v[16:17], v14 offset:0
ds_read_b64_tr_b16 v[18:19], v14 offset:8
ds_read_b128 v[104:107], v15 offset:512
ds_read_b64_tr_b16 v[20:21], v14 offset:512
ds_read_b64_tr_b16 v[22:23], v14 offset:520
ds_read_b128 v[100:103], v15 offset:1024
ds_read_b64_tr_b16 v[24:25], v14 offset:1024
ds_read_b64_tr_b16 v[26:27], v14 offset:1032
ds_read_b128 v[96:99], v15 offset:1536
ds_read_b64_tr_b16 v[28:29], v14 offset:1536
ds_read_b64_tr_b16 v[30:31], v14 offset:1544
ds_read_b128 v[92:95], v15 offset:2048
ds_read_b64_tr_b16 v[32:33], v14 offset:2048
ds_read_b64_tr_b16 v[34:35], v14 offset:2056
ds_read_b128 v[88:91], v15 offset:2560
ds_read_b64_tr_b16 v[36:37], v14 offset:2560
ds_read_b64_tr_b16 v[38:39], v14 offset:2568
ds_read_b128 v[84:87], v15 offset:3072
ds_read_b64_tr_b16 v[40:41], v14 offset:3072
ds_read_b64_tr_b16 v[42:43], v14 offset:3080
ds_read_b128 v[80:83], v15 offset:3584
ds_read_b64_tr_b16 v[44:45], v14 offset:3584
ds_read_b64_tr_b16 v[46:47], v14 offset:3592
v_lshlrev_b32 v5, 3, v6
v_add_u32 v7, v7, v5
s_add_u32 s6, s6, 24
v_sub_u32 v13, s6, v7
v_and_b32 v5, 1, v6
v_mul_u32_u24 v5, 504, v5
v_add_u32 v7, v7, v5
v_lshrrev_b32 v184, 3, v0
s_lshl_b32 s4, s80, 3
v_add_u32 v184, s4, v184
v_and_b32 v185, 7, v0
v_mul_u32_u24 v186, 896, v184
v_lshl_add_u32 v186, v185, 4, v186
s_mul_i32 s78, s90, 57344
s_lshl_b32 s4, s91, 7
s_add_u32 s78, s78, s4
s_add_u32 s79, s78, 28672
s_lshr_b32 s96, s90, 1
s_lshl_b32 s4, s96, 7
s_add_u32 s4, s4, 11026432
v_mov_b32 v187, s4
s_lshl_b32 s4, s90, 1
s_mul_i32 s4, s4, 112
s_mul_i32 s5, s80, 28
s_add_u32 s4, s4, s5
s_lshl_b32 s74, s4, 10
v_add_u32 v176, 68096, v3
v_add_u32 v177, 68096, v4
s_sub_u32 s4, 102144, s42
v_add_u32 v178, s4, v3
v_add_u32 v179, s4, v4
s_waitcnt lgkmcnt(0)
v_mfma_f32_16x16x32_bf16 v[172:175], v[16:19], v[108:111], 0
ds_read_b128 v[140:143], v15 offset:64
ds_read_b64_tr_b16 v[48:49], v14 offset:64
v_mfma_f32_16x16x32_bf16 v[168:171], v[16:19], v[104:107], 0
ds_read_b64_tr_b16 v[50:51], v14 offset:72
v_mfma_f32_16x16x32_bf16 v[172:175], v[20:23], v[104:107], v[172:175]
ds_read_b128 v[136:139], v15 offset:576
ds_read_b64_tr_b16 v[52:53], v14 offset:576
v_mfma_f32_16x16x32_bf16 v[164:167], v[16:19], v[100:103], 0
ds_read_b64_tr_b16 v[54:55], v14 offset:584
v_mfma_f32_16x16x32_bf16 v[168:171], v[20:23], v[100:103], v[168:171]
ds_read_b128 v[132:135], v15 offset:1088
ds_read_b64_tr_b16 v[56:57], v14 offset:1088
v_mfma_f32_16x16x32_bf16 v[172:175], v[24:27], v[100:103], v[172:175]
ds_read_b64_tr_b16 v[58:59], v14 offset:1096
v_mfma_f32_16x16x32_bf16 v[160:163], v[16:19], v[96:99], 0
ds_read_b128 v[128:131], v15 offset:1600
ds_read_b64_tr_b16 v[60:61], v14 offset:1600
v_mfma_f32_16x16x32_bf16 v[164:167], v[20:23], v[96:99], v[164:167]
ds_read_b64_tr_b16 v[62:63], v14 offset:1608
v_mfma_f32_16x16x32_bf16 v[168:171], v[24:27], v[96:99], v[168:171]
ds_read_b128 v[124:127], v15 offset:2112
ds_read_b64_tr_b16 v[64:65], v14 offset:2112
v_mfma_f32_16x16x32_bf16 v[172:175], v[28:31], v[96:99], v[172:175]
ds_read_b64_tr_b16 v[66:67], v14 offset:2120
v_mfma_f32_16x16x32_bf16 v[156:159], v[16:19], v[92:95], 0
ds_read_b128 v[120:123], v15 offset:2624
ds_read_b64_tr_b16 v[68:69], v14 offset:2624
v_mfma_f32_16x16x32_bf16 v[160:163], v[20:23], v[92:95], v[160:163]
ds_read_b64_tr_b16 v[70:71], v14 offset:2632
v_mfma_f32_16x16x32_bf16 v[164:167], v[24:27], v[92:95], v[164:167]
ds_read_b128 v[116:119], v15 offset:3136
ds_read_b64_tr_b16 v[72:73], v14 offset:3136
v_mfma_f32_16x16x32_bf16 v[168:171], v[28:31], v[92:95], v[168:171]
ds_read_b64_tr_b16 v[74:75], v14 offset:3144
v_mfma_f32_16x16x32_bf16 v[172:175], v[32:35], v[92:95], v[172:175]
ds_read_b128 v[112:115], v15 offset:3648
ds_read_b64_tr_b16 v[76:77], v14 offset:3648
v_mfma_f32_16x16x32_bf16 v[152:155], v[16:19], v[88:91], 0
ds_read_b64_tr_b16 v[78:79], v14 offset:3656
v_mfma_f32_16x16x32_bf16 v[156:159], v[20:23], v[88:91], v[156:159]
ds_read_b64_tr_b16 a[0:1], v3 offset:0
v_mfma_f32_16x16x32_bf16 v[160:163], v[24:27], v[88:91], v[160:163]
ds_read_b64_tr_b16 a[2:3], v3 offset:1024
v_mfma_f32_16x16x32_bf16 v[164:167], v[28:31], v[88:91], v[164:167]
ds_read_b64_tr_b16 a[4:5], v4 offset:0
v_mfma_f32_16x16x32_bf16 v[168:171], v[32:35], v[88:91], v[168:171]
ds_read_b64_tr_b16 a[6:7], v4 offset:1024
ds_read_b64_tr_b16 a[8:9], v3 offset:2048
v_mfma_f32_16x16x32_bf16 v[172:175], v[36:39], v[88:91], v[172:175]
ds_read_b64_tr_b16 a[10:11], v3 offset:3072
v_mfma_f32_16x16x32_bf16 v[148:151], v[16:19], v[84:87], 0
ds_read_b64_tr_b16 a[12:13], v4 offset:2048
ds_read_b64_tr_b16 a[14:15], v4 offset:3072
v_mfma_f32_16x16x32_bf16 v[152:155], v[20:23], v[84:87], v[152:155]
ds_read_b64_tr_b16 a[16:17], v3 offset:4096
v_mfma_f32_16x16x32_bf16 v[156:159], v[24:27], v[84:87], v[156:159]
ds_read_b64_tr_b16 a[18:19], v3 offset:5120
ds_read_b64_tr_b16 a[20:21], v4 offset:4096
v_mfma_f32_16x16x32_bf16 v[160:163], v[28:31], v[84:87], v[160:163]
ds_read_b64_tr_b16 a[22:23], v4 offset:5120
v_mfma_f32_16x16x32_bf16 v[164:167], v[32:35], v[84:87], v[164:167]
ds_read_b64_tr_b16 a[24:25], v3 offset:6144
ds_read_b64_tr_b16 a[26:27], v3 offset:7168
v_mfma_f32_16x16x32_bf16 v[168:171], v[36:39], v[84:87], v[168:171]
ds_read_b64_tr_b16 a[28:29], v4 offset:6144
v_mfma_f32_16x16x32_bf16 v[172:175], v[40:43], v[84:87], v[172:175]
ds_read_b64_tr_b16 a[30:31], v4 offset:7168
ds_read_b64_tr_b16 a[32:33], v3 offset:34048
v_mfma_f32_16x16x32_bf16 v[144:147], v[16:19], v[80:83], 0
ds_read_b64_tr_b16 a[34:35], v3 offset:35072
v_mfma_f32_16x16x32_bf16 v[148:151], v[20:23], v[80:83], v[148:151]
ds_read_b64_tr_b16 a[36:37], v4 offset:34048
ds_read_b64_tr_b16 a[38:39], v4 offset:35072
v_mfma_f32_16x16x32_bf16 v[152:155], v[24:27], v[80:83], v[152:155]
ds_read_b64_tr_b16 a[40:41], v3 offset:36096
v_mfma_f32_16x16x32_bf16 v[156:159], v[28:31], v[80:83], v[156:159]
ds_read_b64_tr_b16 a[42:43], v3 offset:37120
ds_read_b64_tr_b16 a[44:45], v4 offset:36096
v_mfma_f32_16x16x32_bf16 v[160:163], v[32:35], v[80:83], v[160:163]
ds_read_b64_tr_b16 a[46:47], v4 offset:37120
v_mfma_f32_16x16x32_bf16 v[164:167], v[36:39], v[80:83], v[164:167]
ds_read_b64_tr_b16 a[48:49], v3 offset:38144
ds_read_b64_tr_b16 a[50:51], v3 offset:39168
v_mfma_f32_16x16x32_bf16 v[168:171], v[40:43], v[80:83], v[168:171]
ds_read_b64_tr_b16 a[52:53], v4 offset:38144
v_mfma_f32_16x16x32_bf16 v[172:175], v[44:47], v[80:83], v[172:175]
ds_read_b64_tr_b16 a[54:55], v4 offset:39168
s_waitcnt lgkmcnt(14)
s_waitcnt vmcnt(0)
s_barrier
s_lshl_b32 s4, s81, 7
s_add_u32 s4, s4, 11026432
v_mov_b32 v9, s4
s_cmp_lg_u32 s80, 0
s_cbranch_scc1 Lsig_9
v_mov_b32 v10, 1
s_mov_b64 exec, 1
global_atomic_add v9, v10, s[40:41] sc1
s_mov_b64 exec, -1
Lsig_9:
buffer_load_dwordx4 a[224:227], v186, s[44:47], s78 offen
buffer_load_dwordx4 a[228:231], v186, s[44:47], s79 offen
v_mfma_f32_16x16x32_bf16 v[172:175], v[48:51], v[140:143], v[172:175]
ds_read_b128 v[108:111], v15 offset:128
ds_read_b64_tr_b16 v[16:17], v14 offset:128
v_mfma_f32_16x16x32_bf16 v[168:171], v[48:51], v[136:139], v[168:171]
ds_read_b64_tr_b16 v[18:19], v14 offset:136
ds_read_b128 v[104:107], v15 offset:640
v_mfma_f32_16x16x32_bf16 v[172:175], v[52:55], v[136:139], v[172:175]
ds_read_b64_tr_b16 v[20:21], v14 offset:640
v_mfma_f32_16x16x32_bf16 v[164:167], v[48:51], v[132:135], v[164:167]
ds_read_b64_tr_b16 v[22:23], v14 offset:648
ds_read_b128 v[100:103], v15 offset:1152
v_mfma_f32_16x16x32_bf16 v[168:171], v[52:55], v[132:135], v[168:171]
ds_read_b64_tr_b16 v[24:25], v14 offset:1152
ds_read_b64_tr_b16 v[26:27], v14 offset:1160
v_mfma_f32_16x16x32_bf16 v[172:175], v[56:59], v[132:135], v[172:175]
ds_read_b128 v[96:99], v15 offset:1664
v_mfma_f32_16x16x32_bf16 v[160:163], v[48:51], v[128:131], v[160:163]
ds_read_b64_tr_b16 v[28:29], v14 offset:1664
ds_read_b64_tr_b16 v[30:31], v14 offset:1672
v_mfma_f32_16x16x32_bf16 v[164:167], v[52:55], v[128:131], v[164:167]
ds_read_b128 v[92:95], v15 offset:2176
ds_read_b64_tr_b16 v[32:33], v14 offset:2176
v_mfma_f32_16x16x32_bf16 v[168:171], v[56:59], v[128:131], v[168:171]
ds_read_b64_tr_b16 v[34:35], v14 offset:2184
v_mfma_f32_16x16x32_bf16 v[172:175], v[60:63], v[128:131], v[172:175]
ds_read_b128 v[88:91], v15 offset:2688
ds_read_b64_tr_b16 v[36:37], v14 offset:2688
v_mfma_f32_16x16x32_bf16 v[156:159], v[48:51], v[124:127], v[156:159]
ds_read_b64_tr_b16 v[38:39], v14 offset:2696
ds_read_b128 v[84:87], v15 offset:3200
v_mfma_f32_16x16x32_bf16 v[160:163], v[52:55], v[124:127], v[160:163]
ds_read_b64_tr_b16 v[40:41], v14 offset:3200
v_mfma_f32_16x16x32_bf16 v[164:167], v[56:59], v[124:127], v[164:167]
ds_read_b64_tr_b16 v[42:43], v14 offset:3208
ds_read_b128 v[80:83], v15 offset:3712
v_mfma_f32_16x16x32_bf16 v[168:171], v[60:63], v[124:127], v[168:171]
ds_read_b64_tr_b16 v[44:45], v14 offset:3712
v_mfma_f32_16x16x32_bf16 v[172:175], v[64:67], v[124:127], v[172:175]
ds_read_b64_tr_b16 v[46:47], v14 offset:3720
s_waitcnt lgkmcnt(14)
s_nop 0
v_mfma_f32_16x16x32_bf16 v[152:155], v[48:51], v[120:123], v[152:155]
ds_read_b64_tr_b16 a[56:57], v3 offset:40192
ds_read_b64_tr_b16 a[58:59], v3 offset:41216
v_mfma_f32_16x16x32_bf16 v[156:159], v[52:55], v[120:123], v[156:159]
ds_read_b64_tr_b16 a[60:61], v4 offset:40192
v_mfma_f32_16x16x32_bf16 v[160:163], v[56:59], v[120:123], v[160:163]
s_add_u32 m0, s93, 0
s_nop 0
s_add_u32 s7, s75, 32768
buffer_load_dwordx4 v2, s[56:59], s7 offen offset:0 lds
ds_read_b64_tr_b16 a[62:63], v4 offset:41216
v_mfma_f32_16x16x32_bf16 v[164:167], v[60:63], v[120:123], v[164:167]
ds_read_b64_tr_b16 a[64:65], v176 offset:0
ds_read_b64_tr_b16 a[66:67], v176 offset:1024
v_mfma_f32_16x16x32_bf16 v[168:171], v[64:67], v[120:123], v[168:171]
ds_read_b64_tr_b16 a[68:69], v177 offset:0
v_mfma_f32_16x16x32_bf16 v[172:175], v[68:71], v[120:123], v[172:175]
s_add_u32 s7, s75, 38912
buffer_load_dwordx4 v2, s[56:59], s7 offen offset:1024 lds
ds_read_b64_tr_b16 a[70:71], v177 offset:1024
v_mfma_f32_16x16x32_bf16 v[148:151], v[48:51], v[116:119], v[148:151]
ds_read_b64_tr_b16 a[72:73], v176 offset:2048
ds_read_b64_tr_b16 a[74:75], v176 offset:3072
v_mfma_f32_16x16x32_bf16 v[152:155], v[52:55], v[116:119], v[152:155]
ds_read_b64_tr_b16 a[76:77], v177 offset:2048
v_mfma_f32_16x16x32_bf16 v[156:159], v[56:59], v[116:119], v[156:159]
ds_read_b64_tr_b16 a[78:79], v177 offset:3072
s_add_u32 s7, s75, 45056
buffer_load_dwordx4 v2, s[56:59], s7 offen offset:2048 lds
v_mfma_f32_16x16x32_bf16 v[160:163], v[60:63], v[116:119], v[160:163]
ds_read_b64_tr_b16 a[80:81], v176 offset:4096
v_mfma_f32_16x16x32_bf16 v[164:167], v[64:67], v[116:119], v[164:167]
ds_read_b64_tr_b16 a[82:83], v176 offset:5120
ds_read_b64_tr_b16 a[84:85], v177 offset:4096
v_mfma_f32_16x16x32_bf16 v[168:171], v[68:71], v[116:119], v[168:171]
ds_read_b64_tr_b16 a[86:87], v177 offset:5120
ds_read_b64_tr_b16 a[88:89], v176 offset:6144
v_mfma_f32_16x16x32_bf16 v[172:175], v[72:75], v[116:119], v[172:175]
s_add_u32 s7, s75, 51200
buffer_load_dwordx4 v2, s[56:59], s7 offen offset:3072 lds
v_mfma_f32_16x16x32_bf16 v[144:147], v[48:51], v[112:115], v[144:147]
ds_read_b64_tr_b16 a[90:91], v176 offset:7168
ds_read_b64_tr_b16 a[92:93], v177 offset:6144
v_mfma_f32_16x16x32_bf16 v[148:151], v[52:55], v[112:115], v[148:151]
ds_read_b64_tr_b16 a[94:95], v177 offset:7168
ds_read_b64_tr_b16 a[96:97], v178 offset:0
v_mfma_f32_16x16x32_bf16 v[152:155], v[56:59], v[112:115], v[152:155]
s_add_u32 s7, s43, 4
s_sub_u32 s75, s7, 7
s_min_u32 s7, s7, s75
s_mul_i32 s7, s7, 57344
s_add_u32 s75, s7, s92
s_add_u32 m0, s93, 4096
s_add_u32 s7, s75, 4096
buffer_load_dwordx4 v2, s[56:59], s7 offen offset:0 lds
v_mfma_f32_16x16x32_bf16 v[156:159], v[60:63], v[112:115], v[156:159]
ds_read_b64_tr_b16 a[98:99], v178 offset:1024
ds_read_b64_tr_b16 a[100:101], v179 offset:0
v_mfma_f32_16x16x32_bf16 v[160:163], v[64:67], v[112:115], v[160:163]
ds_read_b64_tr_b16 a[102:103], v179 offset:1024
ds_read_b64_tr_b16 a[104:105], v178 offset:2048
v_mfma_f32_16x16x32_bf16 v[164:167], v[68:71], v[112:115], v[164:167]
ds_read_b64_tr_b16 a[106:107], v178 offset:3072
v_mfma_f32_16x16x32_bf16 v[168:171], v[72:75], v[112:115], v[168:171]
s_add_u32 s7, s75, 10240
buffer_load_dwordx4 v2, s[56:59], s7 offen offset:1024 lds
ds_read_b64_tr_b16 a[108:109], v179 offset:2048
v_mfma_f32_16x16x32_bf16 v[172:175], v[76:79], v[112:115], v[172:175]
ds_read_b64_tr_b16 a[110:111], v179 offset:3072
s_waitcnt lgkmcnt(14)
s_nop 0
global_load_dword v188, v187, s[40:41] sc1
v_mfma_f32_16x16x32_bf16 v[172:175], v[16:19], v[108:111], v[172:175]
ds_read_b128 v[140:143], v15 offset:192
s_add_u32 s7, s75, 16384
buffer_load_dwordx4 v2, s[56:59], s7 offen offset:2048 lds
v_mfma_f32_16x16x32_bf16 v[168:171], v[16:19], v[104:107], v[168:171]
ds_read_b64_tr_b16 v[48:49], v14 offset:192
v_mfma_f32_16x16x32_bf16 v[172:175], v[20:23], v[104:107], v[172:175]
ds_read_b64_tr_b16 v[50:51], v14 offset:200
v_mfma_f32_16x16x32_bf16 v[164:167], v[16:19], v[100:103], v[164:167]
s_add_u32 s7, s75, 22528
buffer_load_dwordx4 v2, s[56:59], s7 offen offset:3072 lds
v_mfma_f32_16x16x32_bf16 v[168:171], v[20:23], v[100:103], v[168:171]
ds_read_b128 v[136:139], v15 offset:704
v_mfma_f32_16x16x32_bf16 v[172:175], v[24:27], v[100:103], v[172:175]
ds_read_b64_tr_b16 v[52:53], v14 offset:704
v_mfma_f32_16x16x32_bf16 v[160:163], v[16:19], v[96:99], v[160:163]
s_add_u32 m0, s93, 34048
s_add_u32 s7, s75, 32768
buffer_load_dwordx4 v2, s[56:59], s7 offen offset:0 lds
v_mfma_f32_16x16x32_bf16 v[164:167], v[20:23], v[96:99], v[164:167]
ds_read_b64_tr_b16 v[54:55], v14 offset:712
v_mfma_f32_16x16x32_bf16 v[168:171], v[24:27], v[96:99], v[168:171]
ds_read_b128 v[132:135], v15 offset:1216
v_mfma_f32_16x16x32_bf16 v[172:175], v[28:31], v[96:99], v[172:175]
s_add_u32 s7, s75, 38912
buffer_load_dwordx4 v2, s[56:59], s7 offen offset:1024 lds
v_mfma_f32_16x16x32_bf16 v[156:159], v[16:19], v[92:95], v[156:159]
ds_read_b64_tr_b16 v[56:57], v14 offset:1216
v_mfma_f32_16x16x32_bf16 v[160:163], v[20:23], v[92:95], v[160:163]
ds_read_b64_tr_b16 v[58:59], v14 offset:1224
v_mfma_f32_16x16x32_bf16 v[164:167], v[24:27], v[92:95], v[164:167]
s_add_u32 s7, s75, 45056
buffer_load_dwordx4 v2, s[56:59], s7 offen offset:2048 lds
v_mfma_f32_16x16x32_bf16 v[168:171], v[28:31], v[92:95], v[168:171]
ds_read_b128 v[128:131], v15 offset:1728
v_mfma_f32_16x16x32_bf16 v[172:175], v[32:35], v[92:95], v[172:175]
ds_read_b64_tr_b16 v[60:61], v14 offset:1728
v_mfma_f32_16x16x32_bf16 v[152:155], v[16:19], v[88:91], v[152:155]
s_add_u32 s7, s75, 51200
buffer_load_dwordx4 v2, s[56:59], s7 offen offset:3072 lds
v_mfma_f32_16x16x32_bf16 v[156:159], v[20:23], v[88:91], v[156:159]
ds_read_b64_tr_b16 v[62:63], v14 offset:1736
v_mfma_f32_16x16x32_bf16 v[160:163], v[24:27], v[88:91], v[160:163]
s_add_u32 s7, s43, 5
s_sub_u32 s75, s7, 7
s_min_u32 s7, s7, s75
s_mul_i32 s7, s7, 57344
s_add_u32 s75, s7, s92
s_add_u32 m0, s93, 38144
s_add_u32 s7, s75, 4096
buffer_load_dwordx4 v2, s[56:59], s7 offen offset:0 lds
v_mfma_f32_16x16x32_bf16 v[164:167], v[28:31], v[88:91], v[164:167]
ds_read_b128 v[124:127], v15 offset:2240
v_mfma_f32_16x16x32_bf16 v[168:171], v[32:35], v[88:91], v[168:171]
ds_read_b64_tr_b16 v[64:65], v14 offset:2240
v_mfma_f32_16x16x32_bf16 v[172:175], v[36:39], v[88:91], v[172:175]
s_add_u32 s7, s75, 10240
buffer_load_dwordx4 v2, s[56:59], s7 offen offset:1024 lds
v_mfma_f32_16x16x32_bf16 v[148:151], v[16:19], v[84:87], v[148:151]
ds_read_b64_tr_b16 v[66:67], v14 offset:2248
v_mfma_f32_16x16x32_bf16 v[152:155], v[20:23], v[84:87], v[152:155]
ds_read_b128 v[120:123], v15 offset:2752
v_mfma_f32_16x16x32_bf16 v[156:159], v[24:27], v[84:87], v[156:159]
s_waitcnt lgkmcnt(14)
s_nop 0
v_mfma_f32_16x16x32_bf16 v[160:163], v[28:31], v[84:87], v[160:163]
ds_read_b64_tr_b16 v[68:69], v14 offset:2752
v_mfma_f32_16x16x32_bf16 v[164:167], v[32:35], v[84:87], v[164:167]
ds_read_b64_tr_b16 v[70:71], v14 offset:2760
v_mfma_f32_16x16x32_bf16 v[168:171], v[36:39], v[84:87], v[168:171]
s_add_u32 s7, s75, 16384
buffer_load_dwordx4 v2, s[56:59], s7 offen offset:2048 lds
v_mfma_f32_16x16x32_bf16 v[172:175], v[40:43], v[84:87], v[172:175]
ds_read_b128 v[116:119], v15 offset:3264
v_mfma_f32_16x16x32_bf16 v[144:147], v[16:19], v[80:83], v[144:147]
ds_read_b64_tr_b16 v[72:73], v14 offset:3264
v_mfma_f32_16x16x32_bf16 v[148:151], v[20:23], v[80:83], v[148:151]
s_add_u32 s7, s75, 22528
buffer_load_dwordx4 v2, s[56:59], s7 offen offset:3072 lds
v_mfma_f32_16x16x32_bf16 v[152:155], v[24:27], v[80:83], v[152:155]
ds_read_b64_tr_b16 v[74:75], v14 offset:3272
v_mfma_f32_16x16x32_bf16 v[156:159], v[28:31], v[80:83], v[156:159]
ds_read_b128 v[112:115], v15 offset:3776
v_mfma_f32_16x16x32_bf16 v[160:163], v[32:35], v[80:83], v[160:163]
s_add_u32 m0, s93, 68096
s_add_u32 s7, s75, 32768
buffer_load_dwordx4 v2, s[56:59], s7 offen offset:0 lds
v_mfma_f32_16x16x32_bf16 v[164:167], v[36:39], v[80:83], v[164:167]
ds_read_b64_tr_b16 v[76:77], v14 offset:3776
v_mfma_f32_16x16x32_bf16 v[168:171], v[40:43], v[80:83], v[168:171]
ds_read_b64_tr_b16 v[78:79], v14 offset:3784
v_mfma_f32_16x16x32_bf16 v[172:175], v[44:47], v[80:83], v[172:175]
s_add_u32 s7, s75, 38912
buffer_load_dwordx4 v2, s[56:59], s7 offen offset:1024 lds
s_waitcnt lgkmcnt(0)
s_nop 0
v_mfma_f32_16x16x32_bf16 v[172:175], v[48:51], v[140:143], v[172:175]
s_add_u32 s7, s75, 45056
buffer_load_dwordx4 v2, s[56:59], s7 offen offset:2048 lds
v_mfma_f32_16x16x32_bf16 v[168:171], v[48:51], v[136:139], v[168:171]
v_mfma_f32_16x16x32_bf16 v[172:175], v[52:55], v[136:139], v[172:175]
s_add_u32 s7, s75, 51200
buffer_load_dwordx4 v2, s[56:59], s7 offen offset:3072 lds
v_mfma_f32_16x16x32_bf16 v[164:167], v[48:51], v[132:135], v[164:167]
v_mfma_f32_16x16x32_bf16 v[168:171], v[52:55], v[132:135], v[168:171]
s_add_u32 s7, s43, 6
s_sub_u32 s75, s7, 7
s_min_u32 s7, s7, s75
s_mul_i32 s7, s7, 57344
s_add_u32 s75, s7, s92
s_add_u32 m0, s93, 72192
s_add_u32 s7, s75, 4096
buffer_load_dwordx4 v2, s[56:59], s7 offen offset:0 lds
v_mfma_f32_16x16x32_bf16 v[172:175], v[56:59], v[132:135], v[172:175]
v_mfma_f32_16x16x32_bf16 v[160:163], v[48:51], v[128:131], v[160:163]
s_add_u32 s7, s75, 10240
buffer_load_dwordx4 v2, s[56:59], s7 offen offset:1024 lds
v_mfma_f32_16x16x32_bf16 v[164:167], v[52:55], v[128:131], v[164:167]
v_mfma_f32_16x16x32_bf16 v[168:171], v[56:59], v[128:131], v[168:171]
s_add_u32 s7, s75, 16384
buffer_load_dwordx4 v2, s[56:59], s7 offen offset:2048 lds
v_mfma_f32_16x16x32_bf16 v[172:175], v[60:63], v[128:131], v[172:175]
v_mfma_f32_16x16x32_bf16 v[156:159], v[48:51], v[124:127], v[156:159]
s_add_u32 s7, s75, 22528
buffer_load_dwordx4 v2, s[56:59], s7 offen offset:3072 lds
v_mfma_f32_16x16x32_bf16 v[160:163], v[52:55], v[124:127], v[160:163]
v_mfma_f32_16x16x32_bf16 v[164:167], v[56:59], v[124:127], v[164:167]
s_add_u32 m0, s42, 102144
s_add_u32 s7, s75, 32768
buffer_load_dwordx4 v2, s[56:59], s7 offen offset:0 lds
v_mfma_f32_16x16x32_bf16 v[168:171], v[60:63], v[124:127], v[168:171]
v_mfma_f32_16x16x32_bf16 v[172:175], v[64:67], v[124:127], v[172:175]
s_add_u32 s7, s75, 38912
buffer_load_dwordx4 v2, s[56:59], s7 offen offset:1024 lds
v_mfma_f32_16x16x32_bf16 v[152:155], v[48:51], v[120:123], v[152:155]
v_mfma_f32_16x16x32_bf16 v[156:159], v[52:55], v[120:123], v[156:159]
s_add_u32 s7, s75, 45056
buffer_load_dwordx4 v2, s[56:59], s7 offen offset:2048 lds
v_mfma_f32_16x16x32_bf16 v[160:163], v[56:59], v[120:123], v[160:163]
v_mfma_f32_16x16x32_bf16 v[164:167], v[60:63], v[120:123], v[164:167]
s_add_u32 s7, s75, 51200
buffer_load_dwordx4 v2, s[56:59], s7 offen offset:3072 lds
v_mfma_f32_16x16x32_bf16 v[168:171], v[64:67], v[120:123], v[168:171]
v_mfma_f32_16x16x32_bf16 v[172:175], v[68:71], v[120:123], v[172:175]
v_mfma_f32_16x16x32_bf16 v[148:151], v[48:51], v[116:119], v[148:151]
v_mfma_f32_16x16x32_bf16 v[152:155], v[52:55], v[116:119], v[152:155]
v_mfma_f32_16x16x32_bf16 v[156:159], v[56:59], v[116:119], v[156:159]
v_mfma_f32_16x16x32_bf16 v[160:163], v[60:63], v[116:119], v[160:163]
v_mfma_f32_16x16x32_bf16 v[164:167], v[64:67], v[116:119], v[164:167]
v_mfma_f32_16x16x32_bf16 v[168:171], v[68:71], v[116:119], v[168:171]
v_mfma_f32_16x16x32_bf16 v[172:175], v[72:75], v[116:119], v[172:175]
v_mfma_f32_16x16x32_bf16 v[144:147], v[48:51], v[112:115], v[144:147]
v_mfma_f32_16x16x32_bf16 v[148:151], v[52:55], v[112:115], v[148:151]
v_mfma_f32_16x16x32_bf16 v[152:155], v[56:59], v[112:115], v[152:155]
v_mfma_f32_16x16x32_bf16 v[156:159], v[60:63], v[112:115], v[156:159]
v_mfma_f32_16x16x32_bf16 v[160:163], v[64:67], v[112:115], v[160:163]
v_mfma_f32_16x16x32_bf16 v[164:167], v[68:71], v[112:115], v[164:167]
v_mfma_f32_16x16x32_bf16 v[168:171], v[72:75], v[112:115], v[168:171]
v_mfma_f32_16x16x32_bf16 v[172:175], v[76:79], v[112:115], v[172:175]
s_waitcnt vmcnt(22)
v_readfirstlane_b32 s6, v188
s_cmp_ge_u32 s6, 14
s_cbranch_scc1 Lok_10
s_mov_b32 s5, 0x40000
Lspin_11:
global_load_dword v188, v187, s[40:41] sc1
s_waitcnt vmcnt(0)
v_readfirstlane_b32 s6, v188
s_sub_u32 s5, s5, 1
s_cmp_ge_u32 s6, 14
s_cbranch_scc1 Lspun_12
s_sleep 1
s_cmp_lg_u32 s5, 0
s_cbranch_scc1 Lspin_11
Lspun_12:
Lok_10:
v_lshlrev_b32 v189, 3, v184
s_lshl_b32 s4, s90, 9
s_add_u32 s4, s4, 11010048
buffer_load_dwordx2 a[232:233], v189, s[52:55], s4 offen sc1
buffer_load_dwordx2 a[234:235], v189, s[52:55], s4 offen offset:256 sc1
s_add_u32 s7, s43, 0
s_sub_u32 s76, s7, 7
s_min_u32 s7, s7, s76
s_lshl_b32 s7, s7, 12
s_add_u32 s76, s7, s74
s_nop 0
s_add_u32 s77, s76, 114688
buffer_load_dwordx4 v[16:19], v1, s[52:55], s76 offen offset:0 sc1
buffer_load_dwordx4 v[20:23], v1, s[52:55], s77 offen offset:0 sc1
buffer_load_dwordx4 v[24:27], v1, s[52:55], s76 offen offset:1024 sc1
buffer_load_dwordx4 v[28:31], v1, s[52:55], s77 offen offset:1024 sc1
buffer_load_dwordx4 v[32:35], v1, s[52:55], s76 offen offset:2048 sc1
buffer_load_dwordx4 v[36:39], v1, s[52:55], s77 offen offset:2048 sc1
buffer_load_dwordx4 v[40:43], v1, s[52:55], s76 offen offset:3072 sc1
buffer_load_dwordx4 v[44:47], v1, s[52:55], s77 offen offset:3072 sc1
s_lshl_b32 s4, s80, 12
s_add_u32 s4, s4, 118528
v_add_u32 v5, s4, v1
s_xor_b32 s5, s80, 1
s_lshl_b32 s5, s5, 12
s_add_u32 s5, s5, 118528
v_add_u32 v6, s5, v1
s_lshl_b32 s6, s94, 12
s_add_u32 s6, s6, 9175040
s_barrier
s_nop 1
s_bitcmp1_b32 s80, 0
s_cbranch_scc1 Lcodd_13
ds_write_b128 v5, v[160:163] offset:0
ds_write_b128 v5, v[164:167] offset:1024
ds_write_b128 v5, v[168:171] offset:2048
ds_write_b128 v5, v[172:175] offset:3072
ds_read_b64 v[64:65], v13 offset:3584
ds_read_b64 v[66:67], v13 offset:3072
ds_read_b64 v[68:69], v13 offset:2560
ds_read_b64 v[70:71], v13 offset:2048
s_waitcnt lgkmcnt(0)
s_barrier
ds_read_b128 v[48:51], v6 offset:0
ds_read_b128 v[52:55], v6 offset:1024
ds_read_b128 v[56:59], v6 offset:2048
ds_read_b128 v[60:63], v6 offset:3072
v_and_b32 v112, s88, v65
v_lshlrev_b32 v113, 16, v65
v_and_b32 v114, s88, v64
v_lshlrev_b32 v115, 16, v64
v_fmac_f32 v144, v112, v8
v_fmac_f32 v145, v113, v8
v_fmac_f32 v146, v114, v8
v_fmac_f32 v147, v115, v8
v_and_b32 v116, s88, v67
v_lshlrev_b32 v117, 16, v67
v_and_b32 v118, s88, v66
v_lshlrev_b32 v119, 16, v66
v_fmac_f32 v148, v116, v8
v_fmac_f32 v149, v117, v8
v_fmac_f32 v150, v118, v8
v_fmac_f32 v151, v119, v8
v_and_b32 v120, s88, v69
v_lshlrev_b32 v121, 16, v69
v_and_b32 v122, s88, v68
v_lshlrev_b32 v123, 16, v68
v_fmac_f32 v152, v120, v8
v_fmac_f32 v153, v121, v8
v_fmac_f32 v154, v122, v8
v_fmac_f32 v155, v123, v8
v_and_b32 v124, s88, v71
v_lshlrev_b32 v125, 16, v71
v_and_b32 v126, s88, v70
v_lshlrev_b32 v127, 16, v70
v_fmac_f32 v156, v124, v8
v_fmac_f32 v157, v125, v8
v_fmac_f32 v158, v126, v8
v_fmac_f32_e64 v159, v127, v8
s_waitcnt lgkmcnt(0)
v_pk_add_f32 v[144:145], v[144:145], v[48:49]
v_pk_add_f32 v[146:147], v[146:147], v[50:51]
v_pk_add_f32 v[148:149], v[148:149], v[52:53]
v_pk_add_f32 v[150:151], v[150:151], v[54:55]
v_pk_add_f32 v[152:153], v[152:153], v[56:57]
v_pk_add_f32 v[154:155], v[154:155], v[58:59]
v_pk_add_f32 v[156:157], v[156:157], v[60:61]
v_pk_add_f32 v[158:159], v[158:159], v[62:63]
v_cvt_pk_bf16_f32 v72, v144, v145
v_cvt_pk_bf16_f32 v73, v146, v147
v_cvt_pk_bf16_f32 v74, v148, v149
v_cvt_pk_bf16_f32 v75, v150, v151
v_cvt_pk_bf16_f32 v76, v152, v153
v_cvt_pk_bf16_f32 v77, v154, v155
v_cvt_pk_bf16_f32 v78, v156, v157
v_cvt_pk_bf16_f32 v79, v158, v159
s_nop 1
v_permlane16_swap_b32 v72, v74
v_permlane16_swap_b32 v73, v75
v_permlane16_swap_b32 v76, v78
v_permlane16_swap_b32 v77, v79
s_nop 0
buffer_store_dwordx4 v[72:75], v7, s[52:55], s6 offen offset:0 sc1
buffer_store_dwordx4 v[76:79], v7, s[52:55], s6 offen offset:1024 sc1
s_branch Lcend_14
Lcodd_13:
s_nop 0
ds_write_b128 v5, v[144:147] offset:0
ds_write_b128 v5, v[148:151] offset:1024
ds_write_b128 v5, v[152:155] offset:2048
ds_write_b128 v5, v[156:159] offset:3072
ds_read_b64 v[64:65], v13 offset:1536
ds_read_b64 v[66:67], v13 offset:1024
ds_read_b64 v[68:69], v13 offset:512
ds_read_b64 v[70:71], v13 offset:0
s_waitcnt lgkmcnt(0)
s_barrier
ds_read_b128 v[48:51], v6 offset:0
ds_read_b128 v[52:55], v6 offset:1024
ds_read_b128 v[56:59], v6 offset:2048
ds_read_b128 v[60:63], v6 offset:3072
v_and_b32 v112, s88, v65
v_lshlrev_b32 v113, 16, v65
v_and_b32 v114, s88, v64
v_lshlrev_b32 v115, 16, v64
v_fmac_f32 v160, v112, v8
v_fmac_f32 v161, v113, v8
v_fmac_f32 v162, v114, v8
v_fmac_f32 v163, v115, v8
v_and_b32 v116, s88, v67
v_lshlrev_b32 v117, 16, v67
v_and_b32 v118, s88, v66
v_lshlrev_b32 v119, 16, v66
v_fmac_f32 v164, v116, v8
v_fmac_f32 v165, v117, v8
v_fmac_f32 v166, v118, v8
v_fmac_f32 v167, v119, v8
v_and_b32 v120, s88, v69
v_lshlrev_b32 v121, 16, v69
v_and_b32 v122, s88, v68
v_lshlrev_b32 v123, 16, v68
v_fmac_f32 v168, v120, v8
v_fmac_f32 v169, v121, v8
v_fmac_f32 v170, v122, v8
v_fmac_f32 v171, v123, v8
v_and_b32 v124, s88, v71
v_lshlrev_b32 v125, 16, v71
v_and_b32 v126, s88, v70
v_lshlrev_b32 v127, 16, v70
v_fmac_f32 v172, v124, v8
v_fmac_f32 v173, v125, v8
v_fmac_f32 v174, v126, v8
v_fmac_f32_e64 v175, v127, v8
s_waitcnt lgkmcnt(0)
v_pk_add_f32 v[160:161], v[160:161], v[48:49]
v_pk_add_f32 v[162:163], v[162:163], v[50:51]
v_pk_add_f32 v[164:165], v[164:165], v[52:53]
v_pk_add_f32 v[166:167], v[166:167], v[54:55]
v_pk_add_f32 v[168:169], v[168:169], v[56:57]
v_pk_add_f32 v[170:171], v[170:171], v[58:59]
v_pk_add_f32 v[172:173], v[172:173], v[60:61]
v_pk_add_f32 v[174:175], v[174:175], v[62:63]
v_cvt_pk_bf16_f32 v72, v160, v161
v_cvt_pk_bf16_f32 v73, v162, v163
v_cvt_pk_bf16_f32 v74, v164, v165
v_cvt_pk_bf16_f32 v75, v166, v167
v_cvt_pk_bf16_f32 v76, v168, v169
v_cvt_pk_bf16_f32 v77, v170, v171
v_cvt_pk_bf16_f32 v78, v172, v173
v_cvt_pk_bf16_f32 v79, v174, v175
s_nop 1
v_permlane16_swap_b32 v72, v74
v_permlane16_swap_b32 v73, v75
v_permlane16_swap_b32 v76, v78
v_permlane16_swap_b32 v77, v79
s_nop 0
buffer_store_dwordx4 v[72:75], v7, s[52:55], s6 offen offset:2048 sc1
buffer_store_dwordx4 v[76:79], v7, s[52:55], s6 offen offset:3072 sc1
Lcend_14:
v_mov_b32 v5, v184
v_mov_b32 v6, v185
v_mov_b32 v7, v186
s_add_u32 s7, s43, 1
s_sub_u32 s76, s7, 7
s_min_u32 s7, s7, s76
s_lshl_b32 s7, s7, 12
s_add_u32 s76, s7, s74
s_add_u32 s77, s76, 114688
buffer_load_dwordx4 v[80:83], v1, s[52:55], s76 offen offset:0 sc1
buffer_load_dwordx4 v[84:87], v1, s[52:55], s77 offen offset:0 sc1
buffer_load_dwordx4 v[88:91], v1, s[52:55], s76 offen offset:1024 sc1
buffer_load_dwordx4 v[92:95], v1, s[52:55], s77 offen offset:1024 sc1
buffer_load_dwordx4 v[96:99], v1, s[52:55], s76 offen offset:2048 sc1
buffer_load_dwordx4 v[100:103], v1, s[52:55], s77 offen offset:2048 sc1
buffer_load_dwordx4 v[104:107], v1, s[52:55], s76 offen offset:3072 sc1
buffer_load_dwordx4 v[108:111], v1, s[52:55], s77 offen offset:3072 sc1
s_lshr_b32 s96, s89, 5
s_lshl_b32 s4, s96, 7
s_add_u32 s4, s4, 11028480
v_mov_b32 v9, s4
s_lshl_b32 s97, s91, 7
s_add_u32 s97, s97, 11028480
v_and_b32 v11, 31, v0
v_mul_u32_u24 v11, 272, v11
v_lshrrev_b32 v12, 5, v0
v_lshl_add_u32 v11, v12, 4, v11
s_mul_i32 s4, s80, 17408
s_add_u32 s4, s4, 0
v_add_u32_e64 v11, s4, v11
s_waitcnt vmcnt(16)
v_mfma_f32_32x32x16_bf16 v[192:207], a[0:3], v[16:19], 0
ds_read_b64_tr_b16 a[112:113], v3 offset:0
v_mfma_f32_32x32x16_bf16 v[208:223], a[0:3], v[20:23], 0
ds_read_b64_tr_b16 a[114:115], v3 offset:1024
v_mfma_f32_32x32x16_bf16 v[224:239], a[4:7], v[16:19], 0
ds_read_b64_tr_b16 a[116:117], v4 offset:0
v_mfma_f32_32x32x16_bf16 v[240:255], a[4:7], v[20:23], 0
ds_read_b64_tr_b16 a[118:119], v4 offset:1024
s_waitcnt vmcnt(14)
s_nop 0
v_mfma_f32_32x32x16_bf16 v[192:207], a[8:11], v[24:27], v[192:207]
ds_read_b64_tr_b16 a[120:121], v3 offset:2048
v_mfma_f32_32x32x16_bf16 v[208:223], a[8:11], v[28:31], v[208:223]
ds_read_b64_tr_b16 a[122:123], v3 offset:3072
v_mfma_f32_32x32x16_bf16 v[224:239], a[12:15], v[24:27], v[224:239]
ds_read_b64_tr_b16 a[124:125], v4 offset:2048
v_mfma_f32_32x32x16_bf16 v[240:255], a[12:15], v[28:31], v[240:255]
ds_read_b64_tr_b16 a[126:127], v4 offset:3072
s_waitcnt vmcnt(12)
v_mfma_f32_32x32x16_bf16 v[192:207], a[16:19], v[32:35], v[192:207]
ds_read_b64_tr_b16 a[128:129], v3 offset:4096
v_mfma_f32_32x32x16_bf16 v[208:223], a[16:19], v[36:39], v[208:223]
s_add_u32 s7, s43, 2
s_sub_u32 s76, s7, 7
s_min_u32 s7, s7, s76
s_lshl_b32 s7, s7, 12
s_add_u32 s76, s7, s74
s_add_u32 s77, s76, 114688
buffer_load_dwordx4 v[16:19], v1, s[52:55], s76 offen offset:0 sc1
buffer_load_dwordx4 v[20:23], v1, s[52:55], s77 offen offset:0 sc1
ds_read_b64_tr_b16 a[130:131], v3 offset:5120
v_mfma_f32_32x32x16_bf16 v[224:239], a[20:23], v[32:35], v[224:239]
ds_read_b64_tr_b16 a[132:133], v4 offset:4096
v_mfma_f32_32x32x16_bf16 v[240:255], a[20:23], v[36:39], v[240:255]
buffer_load_dwordx4 v[24:27], v1, s[52:55], s76 offen offset:1024 sc1
buffer_load_dwordx4 v[28:31], v1, s[52:55], s77 offen offset:1024 sc1
ds_read_b64_tr_b16 a[134:135], v4 offset:5120
s_waitcnt vmcnt(12)
s_barrier
s_cmp_lg_u32 s80, 0
s_cbranch_scc1 Lsig_15
v_mov_b32 v8, 1
s_mov_b64 exec, 1
global_atomic_add v9, v8, s[40:41] sc1
s_mov_b64 exec, -1
Lsig_15:
s_nop 0
v_mfma_f32_32x32x16_bf16 v[192:207], a[24:27], v[40:43], v[192:207]
ds_read_b64_tr_b16 a[136:137], v3 offset:6144
v_mfma_f32_32x32x16_bf16 v[208:223], a[24:27], v[44:47], v[208:223]
buffer_load_dwordx4 v[32:35], v1, s[52:55], s76 offen offset:2048 sc1
buffer_load_dwordx4 v[36:39], v1, s[52:55], s77 offen offset:2048 sc1
ds_read_b64_tr_b16 a[138:139], v3 offset:7168
v_mfma_f32_32x32x16_bf16 v[224:239], a[28:31], v[40:43], v[224:239]
ds_read_b64_tr_b16 a[140:141], v4 offset:6144
v_mfma_f32_32x32x16_bf16 v[240:255], a[28:31], v[44:47], v[240:255]
buffer_load_dwordx4 v[40:43], v1, s[52:55], s76 offen offset:3072 sc1
buffer_load_dwordx4 v[44:47], v1, s[52:55], s77 offen offset:3072 sc1
ds_read_b64_tr_b16 a[142:143], v4 offset:7168
s_waitcnt vmcnt(14)
s_nop 0
v_mfma_f32_32x32x16_bf16 v[192:207], a[32:35], v[80:83], v[192:207]
ds_read_b64_tr_b16 a[144:145], v3 offset:34048
v_mfma_f32_32x32x16_bf16 v[208:223], a[32:35], v[84:87], v[208:223]
ds_read_b64_tr_b16 a[146:147], v3 offset:35072
v_mfma_f32_32x32x16_bf16 v[224:239], a[36:39], v[80:83], v[224:239]
s_add_u32 s7, s43, 3
s_sub_u32 s76, s7, 7
s_min_u32 s7, s7, s76
s_lshl_b32 s7, s7, 12
s_add_u32 s76, s7, s74
s_nop 0
s_add_u32 s77, s76, 114688
buffer_load_dwordx4 v[80:83], v1, s[52:55], s76 offen offset:0 sc1
ds_read_b64_tr_b16 a[148:149], v4 offset:34048
v_mfma_f32_32x32x16_bf16 v[240:255], a[36:39], v[84:87], v[240:255]
buffer_load_dwordx4 v[84:87], v1, s[52:55], s77 offen offset:0 sc1
ds_read_b64_tr_b16 a[150:151], v4 offset:35072
s_waitcnt vmcnt(14)
s_nop 0
v_mfma_f32_32x32x16_bf16 v[192:207], a[40:43], v[88:91], v[192:207]
ds_read_b64_tr_b16 a[152:153], v3 offset:36096
v_mfma_f32_32x32x16_bf16 v[208:223], a[40:43], v[92:95], v[208:223]
ds_read_b64_tr_b16 a[154:155], v3 offset:37120
v_mfma_f32_32x32x16_bf16 v[224:239], a[44:47], v[88:91], v[224:239]
buffer_load_dwordx4 v[88:91], v1, s[52:55], s76 offen offset:1024 sc1
ds_read_b64_tr_b16 a[156:157], v4 offset:36096
v_mfma_f32_32x32x16_bf16 v[240:255], a[44:47], v[92:95], v[240:255]
buffer_load_dwordx4 v[92:95], v1, s[52:55], s77 offen offset:1024 sc1
ds_read_b64_tr_b16 a[158:159], v4 offset:37120
s_waitcnt vmcnt(14)
s_nop 0
v_mfma_f32_32x32x16_bf16 v[192:207], a[48:51], v[96:99], v[192:207]
ds_read_b64_tr_b16 a[160:161], v3 offset:38144
v_accvgpr_read_b32 v144, a224
v_accvgpr_read_b32 v145, a225
v_mfma_f32_32x32x16_bf16 v[208:223], a[48:51], v[100:103], v[208:223]
ds_read_b64_tr_b16 a[162:163], v3 offset:39168
v_accvgpr_read_b32 v146, a226
v_accvgpr_read_b32 v147, a227
v_mfma_f32_32x32x16_bf16 v[224:239], a[52:55], v[96:99], v[224:239]
buffer_load_dwordx4 v[96:99], v1, s[52:55], s76 offen offset:2048 sc1
ds_read_b64_tr_b16 a[164:165], v4 offset:38144
v_mfma_f32_32x32x16_bf16 v[240:255], a[52:55], v[100:103], v[240:255]
buffer_load_dwordx4 v[100:103], v1, s[52:55], s77 offen offset:2048 sc1
ds_read_b64_tr_b16 a[166:167], v4 offset:39168
s_waitcnt vmcnt(14)
s_nop 0
v_mfma_f32_32x32x16_bf16 v[192:207], a[56:59], v[104:107], v[192:207]
ds_read_b64_tr_b16 a[168:169], v3 offset:40192
v_accvgpr_read_b32 v148, a232
v_accvgpr_read_b32 v149, a233
v_mfma_f32_32x32x16_bf16 v[208:223], a[56:59], v[108:111], v[208:223]
ds_read_b64_tr_b16 a[170:171], v3 offset:41216
v_lshlrev_b32 v112, 16, v144
v_and_b32 v113, s88, v144
v_mfma_f32_32x32x16_bf16 v[224:239], a[60:63], v[104:107], v[224:239]
buffer_load_dwordx4 v[104:107], v1, s[52:55], s76 offen offset:3072 sc1
ds_read_b64_tr_b16 a[172:173], v4 offset:40192
v_mfma_f32_32x32x16_bf16 v[240:255], a[60:63], v[108:111], v[240:255]
buffer_load_dwordx4 v[108:111], v1, s[52:55], s77 offen offset:3072 sc1
ds_read_b64_tr_b16 a[174:175], v4 offset:41216
s_waitcnt vmcnt(14)
v_mfma_f32_32x32x16_bf16 v[192:207], a[64:67], v[16:19], v[192:207]
ds_read_b64_tr_b16 a[176:177], v176 offset:0
v_lshlrev_b32 v114, 16, v145
v_and_b32_e64 v115, s88, v145
v_mfma_f32_32x32x16_bf16 v[208:223], a[64:67], v[20:23], v[208:223]
ds_read_b64_tr_b16 a[178:179], v176 offset:1024
v_lshlrev_b32 v116, 16, v146
v_and_b32 v117, s88, v146
v_mfma_f32_32x32x16_bf16 v[224:239], a[68:71], v[16:19], v[224:239]
s_add_u32 s7, s43, 4
s_sub_u32 s76, s7, 7
s_min_u32 s7, s7, s76
s_lshl_b32 s7, s7, 12
s_add_u32 s76, s7, s74
s_nop 0
s_add_u32 s77, s76, 114688
buffer_load_dwordx4 v[16:19], v1, s[52:55], s76 offen offset:0 sc1
ds_read_b64_tr_b16 a[180:181], v177 offset:0
v_mfma_f32_32x32x16_bf16 v[240:255], a[68:71], v[20:23], v[240:255]
buffer_load_dwordx4 v[20:23], v1, s[52:55], s77 offen offset:0 sc1
ds_read_b64_tr_b16 a[182:183], v177 offset:1024
s_waitcnt vmcnt(14)
v_mfma_f32_32x32x16_bf16 v[192:207], a[72:75], v[24:27], v[192:207]
ds_read_b64_tr_b16 a[184:185], v176 offset:2048
v_lshlrev_b32 v118, 16, v147
v_and_b32_e64 v119, s88, v147
v_mfma_f32_32x32x16_bf16 v[208:223], a[72:75], v[28:31], v[208:223]
ds_read_b64_tr_b16 a[186:187], v176 offset:3072
v_fma_f32 v120, v112, v148, v149
v_fma_f32 v121, v113, v148, v149
v_mfma_f32_32x32x16_bf16 v[224:239], a[76:79], v[24:27], v[224:239]
buffer_load_dwordx4 v[24:27], v1, s[52:55], s76 offen offset:1024 sc1
ds_read_b64_tr_b16 a[188:189], v177 offset:2048
v_mfma_f32_32x32x16_bf16 v[240:255], a[76:79], v[28:31], v[240:255]
buffer_load_dwordx4 v[28:31], v1, s[52:55], s77 offen offset:1024 sc1
ds_read_b64_tr_b16 a[190:191], v177 offset:3072
s_waitcnt vmcnt(14)
s_nop 0
v_mfma_f32_32x32x16_bf16 v[192:207], a[80:83], v[32:35], v[192:207]
ds_read_b64_tr_b16 a[192:193], v176 offset:4096
v_fma_f32 v122, v114, v148, v149
v_fma_f32 v123, v115, v148, v149
v_mfma_f32_32x32x16_bf16 v[208:223], a[80:83], v[36:39], v[208:223]
ds_read_b64_tr_b16 a[194:195], v176 offset:5120
v_fma_f32 v124, v116, v148, v149
v_fma_f32 v125, v117, v148, v149
v_mfma_f32_32x32x16_bf16 v[224:239], a[84:87], v[32:35], v[224:239]
buffer_load_dwordx4 v[32:35], v1, s[52:55], s76 offen offset:2048 sc1
ds_read_b64_tr_b16 a[196:197], v177 offset:4096
v_mfma_f32_32x32x16_bf16 v[240:255], a[84:87], v[36:39], v[240:255]
buffer_load_dwordx4 v[36:39], v1, s[52:55], s77 offen offset:2048 sc1
ds_read_b64_tr_b16 a[198:199], v177 offset:5120
s_waitcnt vmcnt(14)
s_nop 0
v_mfma_f32_32x32x16_bf16 v[192:207], a[88:91], v[40:43], v[192:207]
ds_read_b64_tr_b16 a[200:201], v176 offset:6144
v_fma_f32 v126, v118, v148, v149
v_fma_f32 v127, v119, v148, v149
v_mfma_f32_32x32x16_bf16 v[208:223], a[88:91], v[44:47], v[208:223]
ds_read_b64_tr_b16 a[202:203], v176 offset:7168
v_mov_b32 v160, 0
v_mov_b32 v161, 0
v_mfma_f32_32x32x16_bf16 v[224:239], a[92:95], v[40:43], v[224:239]
buffer_load_dwordx4 v[40:43], v1, s[52:55], s76 offen offset:3072 sc1
ds_read_b64_tr_b16 a[204:205], v177 offset:6144
v_mfma_f32_32x32x16_bf16 v[240:255], a[92:95], v[44:47], v[240:255]
buffer_load_dwordx4 v[44:47], v1, s[52:55], s77 offen offset:3072 sc1
ds_read_b64_tr_b16 a[206:207], v177 offset:7168
s_waitcnt vmcnt(14)
v_mfma_f32_32x32x16_bf16 v[192:207], a[96:99], v[80:83], v[192:207]
ds_read_b64_tr_b16 a[208:209], v178 offset:0
v_mov_b32 v162, 0
v_mov_b32_e64 v163, 0
v_mfma_f32_32x32x16_bf16 v[208:223], a[96:99], v[84:87], v[208:223]
ds_read_b64_tr_b16 a[210:211], v178 offset:1024
v_mov_b32 v164, 0
v_mov_b32 v165, 0
v_mfma_f32_32x32x16_bf16 v[224:239], a[100:103], v[80:83], v[224:239]
s_add_u32 s7, s43, 5
s_sub_u32 s76, s7, 7
s_min_u32 s7, s7, s76
s_lshl_b32 s7, s7, 12
s_add_u32 s76, s7, s74
s_nop 0
s_add_u32 s77, s76, 114688
buffer_load_dwordx4 v[80:83], v1, s[52:55], s76 offen offset:0 sc1
ds_read_b64_tr_b16 a[212:213], v179 offset:0
v_mfma_f32_32x32x16_bf16 v[240:255], a[100:103], v[84:87], v[240:255]
buffer_load_dwordx4 v[84:87], v1, s[52:55], s77 offen offset:0 sc1
ds_read_b64_tr_b16 a[214:215], v179 offset:1024
s_waitcnt vmcnt(14)
v_mfma_f32_32x32x16_bf16 v[192:207], a[104:107], v[88:91], v[192:207]
ds_read_b64_tr_b16 a[216:217], v178 offset:2048
v_mov_b32 v166, 0
v_mov_b32_e64 v167, 0
v_mfma_f32_32x32x16_bf16 v[208:223], a[104:107], v[92:95], v[208:223]
ds_read_b64_tr_b16 a[218:219], v178 offset:3072
v_accvgpr_read_b32 v152, a228
v_accvgpr_read_b32 v153, a229
v_mfma_f32_32x32x16_bf16 v[224:239], a[108:111], v[88:91], v[224:239]
buffer_load_dwordx4 v[88:91], v1, s[52:55], s76 offen offset:1024 sc1
ds_read_b64_tr_b16 a[220:221], v179 offset:2048
v_mfma_f32_32x32x16_bf16 v[240:255], a[108:111], v[92:95], v[240:255]
buffer_load_dwordx4 v[92:95], v1, s[52:55], s77 offen offset:1024 sc1
ds_read_b64_tr_b16 a[222:223], v179 offset:3072
s_waitcnt vmcnt(14) lgkmcnt(14)
s_nop 0
v_mfma_f32_32x32x16_bf16 v[192:207], a[112:115], v[96:99], v[192:207]
v_accvgpr_read_b32 v154, a230
v_accvgpr_read_b32 v155, a231
v_mfma_f32_32x32x16_bf16 v[208:223], a[112:115], v[100:103], v[208:223]
v_accvgpr_read_b32 v156, a234
v_accvgpr_read_b32 v157, a235
v_mfma_f32_32x32x16_bf16 v[224:239], a[116:119], v[96:99], v[224:239]
buffer_load_dwordx4 v[96:99], v1, s[52:55], s76 offen offset:2048 sc1
v_mfma_f32_32x32x16_bf16 v[240:255], a[116:119], v[100:103], v[240:255]
buffer_load_dwordx4 v[100:103], v1, s[52:55], s77 offen offset:2048 sc1
s_waitcnt vmcnt(14) lgkmcnt(14)
v_mfma_f32_32x32x16_bf16 v[192:207], a[120:123], v[104:107], v[192:207]
v_lshlrev_b32 v128, 16, v152
v_and_b32 v129, s88, v152
v_mfma_f32_32x32x16_bf16 v[208:223], a[120:123], v[108:111], v[208:223]
v_lshlrev_b32 v130, 16, v153
v_and_b32_e64 v131, s88, v153
v_mfma_f32_32x32x16_bf16 v[224:239], a[124:127], v[104:107], v[224:239]
buffer_load_dwordx4 v[104:107], v1, s[52:55], s76 offen offset:3072 sc1
v_mfma_f32_32x32x16_bf16 v[240:255], a[124:127], v[108:111], v[240:255]
buffer_load_dwordx4 v[108:111], v1, s[52:55], s77 offen offset:3072 sc1
s_waitcnt vmcnt(14) lgkmcnt(14)
v_mfma_f32_32x32x16_bf16 v[192:207], a[128:131], v[16:19], v[192:207]
v_lshlrev_b32 v132, 16, v154
v_and_b32 v133, s88, v154
v_mfma_f32_32x32x16_bf16 v[208:223], a[128:131], v[20:23], v[208:223]
v_lshlrev_b32 v134, 16, v155
v_and_b32 v135, s88, v155
v_mfma_f32_32x32x16_bf16 v[224:239], a[132:135], v[16:19], v[224:239]
s_add_u32 s7, s43, 6
s_sub_u32 s76, s7, 7
s_min_u32 s7, s7, s76
s_lshl_b32 s7, s7, 12
s_add_u32 s76, s7, s74
s_add_u32 s77, s76, 114688
buffer_load_dwordx4 v[16:19], v1, s[52:55], s76 offen offset:0 sc1
v_mfma_f32_32x32x16_bf16 v[240:255], a[132:135], v[20:23], v[240:255]
buffer_load_dwordx4 v[20:23], v1, s[52:55], s77 offen offset:0 sc1
s_waitcnt vmcnt(14) lgkmcnt(14)
s_nop 0
v_mfma_f32_32x32x16_bf16 v[192:207], a[136:139], v[24:27], v[192:207]
v_fma_f32 v136, v128, v156, v157
v_fma_f32 v137, v129, v156, v157
v_mfma_f32_32x32x16_bf16 v[208:223], a[136:139], v[28:31], v[208:223]
v_fma_f32 v138, v130, v156, v157
v_fma_f32 v139, v131, v156, v157
v_mfma_f32_32x32x16_bf16 v[224:239], a[140:143], v[24:27], v[224:239]
buffer_load_dwordx4 v[24:27], v1, s[52:55], s76 offen offset:1024 sc1
v_mfma_f32_32x32x16_bf16 v[240:255], a[140:143], v[28:31], v[240:255]
buffer_load_dwordx4 v[28:31], v1, s[52:55], s77 offen offset:1024 sc1
s_waitcnt vmcnt(14) lgkmcnt(14)
s_nop 0
v_mfma_f32_32x32x16_bf16 v[192:207], a[144:147], v[32:35], v[192:207]
v_fma_f32 v140, v132, v156, v157
v_fma_f32 v141, v133, v156, v157
v_mfma_f32_32x32x16_bf16 v[208:223], a[144:147], v[36:39], v[208:223]
v_fma_f32 v142, v134, v156, v157
v_fma_f32 v143, v135, v156, v157
v_mfma_f32_32x32x16_bf16 v[224:239], a[148:151], v[32:35], v[224:239]
buffer_load_dwordx4 v[32:35], v1, s[52:55], s76 offen offset:2048 sc1
v_mfma_f32_32x32x16_bf16 v[240:255], a[148:151], v[36:39], v[240:255]
buffer_load_dwordx4 v[36:39], v1, s[52:55], s77 offen offset:2048 sc1
s_waitcnt vmcnt(14) lgkmcnt(14)
v_mfma_f32_32x32x16_bf16 v[192:207], a[152:155], v[40:43], v[192:207]
v_mov_b32 v168, 0
v_mov_b32 v169, 0
v_mfma_f32_32x32x16_bf16 v[208:223], a[152:155], v[44:47], v[208:223]
v_mov_b32 v170, 0
v_mov_b32_e64 v171, 0
v_mfma_f32_32x32x16_bf16 v[224:239], a[156:159], v[40:43], v[224:239]
buffer_load_dwordx4 v[40:43], v1, s[52:55], s76 offen offset:3072 sc1
v_mfma_f32_32x32x16_bf16 v[240:255], a[156:159], v[44:47], v[240:255]
buffer_load_dwordx4 v[44:47], v1, s[52:55], s77 offen offset:3072 sc1
v_mov_b32 v9, s97
global_load_dword v10, v9, s[40:41] sc1
s_waitcnt vmcnt(15) lgkmcnt(14)
v_mfma_f32_32x32x16_bf16 v[192:207], a[160:163], v[80:83], v[192:207]
v_mov_b32 v172, 0
v_mov_b32 v173, 0
v_mfma_f32_32x32x16_bf16 v[208:223], a[160:163], v[84:87], v[208:223]
v_mov_b32 v174, 0
v_mov_b32 v175, 0
v_mfma_f32_32x32x16_bf16 v[224:239], a[164:167], v[80:83], v[224:239]
v_mfma_f32_32x32x16_bf16 v[240:255], a[164:167], v[84:87], v[240:255]
s_waitcnt vmcnt(13) lgkmcnt(14)
v_mfma_f32_32x32x16_bf16 v[192:207], a[168:171], v[88:91], v[192:207]
v_mfma_f32_32x32x16_bf16 v[208:223], a[168:171], v[92:95], v[208:223]
v_mfma_f32_32x32x16_bf16 v[224:239], a[172:175], v[88:91], v[224:239]
v_mfma_f32_32x32x16_bf16 v[240:255], a[172:175], v[92:95], v[240:255]
s_waitcnt vmcnt(11) lgkmcnt(14)
v_mfma_f32_32x32x16_bf16 v[192:207], a[176:179], v[96:99], v[192:207]
v_mfma_f32_32x32x16_bf16 v[208:223], a[176:179], v[100:103], v[208:223]
v_mfma_f32_32x32x16_bf16 v[224:239], a[180:183], v[96:99], v[224:239]
v_mfma_f32_32x32x16_bf16 v[240:255], a[180:183], v[100:103], v[240:255]
s_waitcnt vmcnt(9) lgkmcnt(14)
v_mfma_f32_32x32x16_bf16 v[192:207], a[184:187], v[104:107], v[192:207]
v_mfma_f32_32x32x16_bf16 v[208:223], a[184:187], v[108:111], v[208:223]
v_mfma_f32_32x32x16_bf16 v[224:239], a[188:191], v[104:107], v[224:239]
v_mfma_f32_32x32x16_bf16 v[240:255], a[188:191], v[108:111], v[240:255]
s_waitcnt vmcnt(0)
v_readfirstlane_b32 s98, v10
s_cmp_ge_u32 s98, 32
s_cbranch_scc1 Lyok_16
v_mov_b32 v9, s97
s_mov_b32 s5, 0x40000
Lspin_17:
global_load_dword v10, v9, s[40:41] sc1
s_waitcnt vmcnt(0)
v_readfirstlane_b32 s6, v10
s_sub_u32 s5, s5, 1
s_cmp_ge_u32 s6, 32
s_cbranch_scc1 Lspun_18
s_sleep 1
s_cmp_lg_u32 s5, 0
s_cbranch_scc1 Lspin_17
Lspun_18:
Lyok_16:
v_lshrrev_b32 v8, 3, v0
v_lshlrev_b32 v8, 12, v8
v_lshl_add_u32 v8, v6, 4, v8
s_lshl_b32 s4, s91, 18
s_lshl_b32 s5, s80, 16
s_add_u32 s4, s4, s5
s_lshl_b32 s5, s90, 7
s_add_u32 s4, s4, s5
s_nop 0
s_add_u32 s4, s4, 9175040
s_mul_i32 s5, s80, 2080
s_add_u32 m0, s5, 134912
s_add_u32 s6, s4, 31728
buffer_load_dwordx4 v8, s[52:55], s4 offen sc1 lds
buffer_load_dwordx4 v8, s[52:55], s6 offen offset:1040 sc1 lds
s_waitcnt lgkmcnt(0)
s_barrier
v_mfma_f32_32x32x16_bf16 v[192:207], a[192:195], v[16:19], v[192:207]
v_mfma_f32_32x32x16_bf16 v[192:207], a[200:203], v[24:27], v[192:207]
v_mfma_f32_32x32x16_bf16 v[192:207], a[208:211], v[32:35], v[192:207]
v_mfma_f32_32x32x16_bf16 v[192:207], a[216:219], v[40:43], v[192:207]
v_mfma_f32_32x32x16_bf16 v[208:223], a[192:195], v[20:23], v[208:223]
v_mfma_f32_32x32x16_bf16 v[208:223], a[200:203], v[28:31], v[208:223]
v_mfma_f32_32x32x16_bf16 v[208:223], a[208:211], v[36:39], v[208:223]
v_mfma_f32_32x32x16_bf16 v[208:223], a[216:219], v[44:47], v[208:223]
v_mfma_f32_32x32x16_bf16 v[224:239], a[196:199], v[16:19], v[224:239]
v_mfma_f32_32x32x16_bf16 v[224:239], a[204:207], v[24:27], v[224:239]
v_mfma_f32_32x32x16_bf16 v[224:239], a[212:215], v[32:35], v[224:239]
v_mfma_f32_32x32x16_bf16 v[224:239], a[220:223], v[40:43], v[224:239]
s_nop 3
s_nop 0
ds_write_b128 v11, v[192:195] offset:0
ds_write_b128 v11, v[196:199] offset:32
ds_write_b128 v11, v[200:203] offset:64
ds_write_b128 v11, v[204:207] offset:96
v_mfma_f32_32x32x16_bf16 v[240:255], a[196:199], v[20:23], v[240:255]
v_mfma_f32_32x32x16_bf16 v[240:255], a[204:207], v[28:31], v[240:255]
v_mfma_f32_32x32x16_bf16 v[240:255], a[212:215], v[36:39], v[240:255]
v_mfma_f32_32x32x16_bf16 v[240:255], a[220:223], v[44:47], v[240:255]
ds_write_b128 v11, v[208:211] offset:8704
ds_write_b128 v11, v[212:215] offset:8736
ds_write_b128 v11, v[216:219] offset:8768
ds_write_b128 v11, v[220:223] offset:8800
v_mov_b32 v10, 0xbfb8aa3b
v_mul_u32_u24 v8, 272, v5
v_lshl_add_u32 v8, v6, 5, v8
v_add_u32_e64 v8, 0, v8
v_mul_u32_u24 v9, 1040, v6
v_lshl_add_u32 v9, v5, 1, v9
v_add_u32 v9, 134912, v9
ds_write_b128 v11, v[224:227] offset:128
ds_write_b128 v11, v[228:231] offset:160
ds_write_b128 v11, v[232:235] offset:192
ds_write_b128 v11, v[236:239] offset:224
ds_write_b128 v11, v[240:243] offset:8832
ds_write_b128 v11, v[244:247] offset:8864
ds_write_b128 v11, v[248:251] offset:8896
ds_write_b128 v11, v[252:255] offset:8928
v_mov_b32_e64 v11, 1.0
s_waitcnt lgkmcnt(0)
s_barrier
ds_read_b128 v[16:19], v8 offset:0
ds_read_b128 v[20:23], v8 offset:16
ds_read_b128 v[24:27], v8 offset:17408
ds_read_b128 v[28:31], v8 offset:17424
ds_read_b128 v[32:35], v8 offset:34816
ds_read_b128 v[36:39], v8 offset:34832
ds_read_b128 v[40:43], v8 offset:52224
ds_read_b128 v[44:47], v8 offset:52240
ds_read_b128 v[80:83], v8 offset:8704
ds_read_b128 v[84:87], v8 offset:8720
ds_read_b128 v[88:91], v8 offset:26112
ds_read_b128 v[92:95], v8 offset:26128
ds_read_b128 v[96:99], v8 offset:43520
ds_read_b128 v[100:103], v8 offset:43536
ds_read_b128 v[104:107], v8 offset:60928
ds_read_b128 v[108:111], v8 offset:60944
s_waitcnt lgkmcnt(8)
s_nop 0
v_pk_add_f32 v[16:17], v[16:17], v[24:25]
v_pk_add_f32 v[32:33], v[32:33], v[40:41]
v_pk_add_f32 v[18:19], v[18:19], v[26:27]
v_pk_add_f32 v[34:35], v[34:35], v[42:43]
v_pk_add_f32 v[20:21], v[20:21], v[28:29]
v_pk_add_f32 v[36:37], v[36:37], v[44:45]
v_pk_add_f32 v[22:23], v[22:23], v[30:31]
v_pk_add_f32 v[38:39], v[38:39], v[46:47]
v_pk_add_f32 v[16:17], v[16:17], v[32:33]
v_pk_add_f32 v[18:19], v[18:19], v[34:35]
v_pk_add_f32 v[20:21], v[20:21], v[36:37]
v_pk_add_f32 v[22:23], v[22:23], v[38:39]
v_pk_mul_f32 v[32:33], v[16:17], v[10:11] op_sel_hi:[1,0]
v_pk_mul_f32 v[34:35], v[18:19], v[10:11] op_sel_hi:[1,0]
v_pk_mul_f32 v[36:37], v[20:21], v[10:11] op_sel_hi:[1,0]
v_pk_mul_f32 v[38:39], v[22:23], v[10:11] op_sel_hi:[1,0]
v_exp_f32 v32, v32
v_exp_f32 v33, v33
v_exp_f32 v34, v34
v_exp_f32 v35, v35
v_exp_f32 v36, v36
v_exp_f32 v37, v37
v_exp_f32 v38, v38
v_exp_f32 v39, v39
v_pk_mul_f32 v[120:121], v[120:121], v[16:17]
v_pk_mul_f32 v[122:123], v[122:123], v[18:19]
v_pk_mul_f32 v[124:125], v[124:125], v[20:21]
v_pk_mul_f32 v[126:127], v[126:127], v[22:23]
v_pk_add_f32 v[32:33], v[32:33], v[10:11] op_sel:[0,1] op_sel_hi:[1,1]
v_pk_add_f32 v[34:35], v[34:35], v[10:11] op_sel:[0,1] op_sel_hi:[1,1]
v_pk_add_f32 v[36:37], v[36:37], v[10:11] op_sel:[0,1] op_sel_hi:[1,1]
v_pk_add_f32 v[38:39], v[38:39], v[10:11] op_sel:[0,1] op_sel_hi:[1,1]
v_rcp_f32 v32, v32
v_rcp_f32 v33, v33
v_rcp_f32 v34, v34
v_rcp_f32 v35, v35
v_rcp_f32 v36, v36
v_rcp_f32 v37, v37
v_rcp_f32 v38, v38
v_rcp_f32_e64 v39, v39
s_nop 0
v_pk_mul_f32 v[120:121], v[120:121], v[32:33]
v_pk_mul_f32 v[122:123], v[122:123], v[34:35]
v_pk_mul_f32 v[124:125], v[124:125], v[36:37]
v_pk_mul_f32 v[126:127], v[126:127], v[38:39]
s_waitcnt lgkmcnt(0)
s_nop 0
v_pk_add_f32 v[80:81], v[80:81], v[88:89]
v_pk_add_f32 v[96:97], v[96:97], v[104:105]
v_pk_add_f32 v[82:83], v[82:83], v[90:91]
v_pk_add_f32 v[98:99], v[98:99], v[106:107]
v_pk_add_f32 v[84:85], v[84:85], v[92:93]
v_pk_add_f32 v[100:101], v[100:101], v[108:109]
v_pk_add_f32 v[86:87], v[86:87], v[94:95]
v_pk_add_f32 v[102:103], v[102:103], v[110:111]
v_pk_add_f32 v[80:81], v[80:81], v[96:97]
v_pk_add_f32 v[82:83], v[82:83], v[98:99]
v_pk_add_f32 v[84:85], v[84:85], v[100:101]
v_pk_add_f32 v[86:87], v[86:87], v[102:103]
v_pk_mul_f32 v[96:97], v[80:81], v[10:11] op_sel_hi:[1,0]
v_pk_mul_f32 v[98:99], v[82:83], v[10:11] op_sel_hi:[1,0]
v_pk_mul_f32 v[100:101], v[84:85], v[10:11] op_sel_hi:[1,0]
v_pk_mul_f32 v[102:103], v[86:87], v[10:11] op_sel_hi:[1,0]
v_exp_f32 v96, v96
v_exp_f32 v97, v97
v_exp_f32 v98, v98
v_exp_f32 v99, v99
v_exp_f32 v100, v100
v_exp_f32 v101, v101
v_exp_f32 v102, v102
v_exp_f32 v103, v103
v_pk_mul_f32 v[136:137], v[136:137], v[80:81]
v_pk_mul_f32 v[138:139], v[138:139], v[82:83]
v_pk_mul_f32 v[140:141], v[140:141], v[84:85]
v_pk_mul_f32 v[142:143], v[142:143], v[86:87]
v_pk_add_f32 v[96:97], v[96:97], v[10:11] op_sel:[0,1] op_sel_hi:[1,1]
v_pk_add_f32 v[98:99], v[98:99], v[10:11] op_sel:[0,1] op_sel_hi:[1,1]
v_pk_add_f32 v[100:101], v[100:101], v[10:11] op_sel:[0,1] op_sel_hi:[1,1]
v_pk_add_f32 v[102:103], v[102:103], v[10:11] op_sel:[0,1] op_sel_hi:[1,1]
v_rcp_f32 v96, v96
v_rcp_f32 v97, v97
v_rcp_f32 v98, v98
v_rcp_f32 v99, v99
v_rcp_f32 v100, v100
v_rcp_f32 v101, v101
v_rcp_f32 v102, v102
v_rcp_f32_e64 v103, v103
s_nop 0
v_pk_mul_f32 v[136:137], v[136:137], v[96:97]
v_pk_mul_f32 v[138:139], v[138:139], v[98:99]
v_pk_mul_f32 v[140:141], v[140:141], v[100:101]
v_pk_mul_f32 v[142:143], v[142:143], v[102:103]
s_waitcnt vmcnt(0)
s_barrier
ds_read_u16_d16_hi v160, v9 offset:0
ds_read_u16_d16_hi v161, v9 offset:128
ds_read_u16_d16_hi v162, v9 offset:256
ds_read_u16_d16_hi v163, v9 offset:384
ds_read_u16_d16_hi v164, v9 offset:512
ds_read_u16_d16_hi v165, v9 offset:640
ds_read_u16_d16_hi v166, v9 offset:768
ds_read_u16_d16_hi v167, v9 offset:896
ds_read_u16_d16_hi v168, v9 offset:64
ds_read_u16_d16_hi v169, v9 offset:192
ds_read_u16_d16_hi v170, v9 offset:320
ds_read_u16_d16_hi v171, v9 offset:448
ds_read_u16_d16_hi v172, v9 offset:576
ds_read_u16_d16_hi v173, v9 offset:704
s_waitcnt lgkmcnt(10)
ds_read_u16_d16_hi v174, v9 offset:832
ds_read_u16_d16_hi v175, v9 offset:960
s_waitcnt lgkmcnt(8)
v_pk_fma_f32 v[120:121], v[120:121], v[160:161], v[112:113]
v_pk_fma_f32 v[122:123], v[122:123], v[162:163], v[114:115]
v_pk_fma_f32 v[124:125], v[124:125], v[164:165], v[116:117]
v_pk_fma_f32 v[126:127], v[126:127], v[166:167], v[118:119]
v_cvt_pk_bf16_f32 v144, v120, v121
v_cvt_pk_bf16_f32 v145, v122, v123
v_cvt_pk_bf16_f32 v146, v124, v125
v_cvt_pk_bf16_f32 v147, v126, v127
buffer_store_dwordx4 v[144:147], v7, s[64:67], s78 offen nt
s_waitcnt lgkmcnt(0)
s_nop 0
v_pk_fma_f32 v[136:137], v[136:137], v[168:169], v[128:129]
v_pk_fma_f32 v[138:139], v[138:139], v[170:171], v[130:131]
v_pk_fma_f32 v[140:141], v[140:141], v[172:173], v[132:133]
v_pk_fma_f32 v[142:143], v[142:143], v[174:175], v[134:135]
v_cvt_pk_bf16_f32 v152, v136, v137
v_cvt_pk_bf16_f32 v153, v138, v139
v_cvt_pk_bf16_f32 v154, v140, v141
v_cvt_pk_bf16_f32 v155, v142, v143
buffer_store_dwordx4 v[152:155], v7, s[64:67], s79 offen nt
s_endpgm
L_pre:
s_sub_u32 s4, s85, 28
s_lshl_b32 s4, s4, 3
s_add_u32 s81, s4, s86
v_lshlrev_b32_e64 v1, 4, v0
s_waitcnt lgkmcnt(0)
s_mov_b32 s52, s40
s_and_b32 s53, s41, 0xffff
s_mov_b32 s54, 11030528
s_mov_b32 s55, 0x20000
s_or_b32 s4, s81, s80
s_cmp_lg_u32 s4, 0
s_cbranch_scc1 Lnolead_19
v_lshlrev_b32 v2, 7, v0
v_add_u32 v2, 11026432, v2
v_mov_b32 v3, 0
s_mov_b32 exec_hi, 0
global_store_dword v2, v3, s[40:41] sc1
s_waitcnt vmcnt(0)
v_mov_b32 v2, 1
s_mov_b64 exec, 1
global_store_dword v3, v2, s[38:39] sc1
s_mov_b64 exec, -1
Lnolead_19:
s_mov_b32 s48, s18
s_and_b32 s49, s19, 0xffff
s_mov_b32 s50, 1835008
s_mov_b32 s51, 0x20000
s_mov_b32 s56, s20
s_and_b32 s57, s21, 0xffff
s_mov_b32 s58, 1835008
s_mov_b32 s59, 0x20000
s_mov_b32 s60, s22
s_and_b32 s61, s23, 0xffff
s_mov_b32 s62, 3584
s_mov_b32 s63, 0x20000
s_mov_b32 exec_hi, 0x00ffffff
s_lshl_b32 s4, s81, 6
s_add_u32 s4, s4, s80
s_sub_u32 s5, s4, 3
s_mul_i32 s5, s5, 896
s_mul_i32 s6, s80, 900
s_add_u32 m0, s6, 0
v_add_u32 v2, s5, v1
buffer_load_dwordx4 v2, s[48:51], 0 offen lds
s_add_u32 m0, m0, 3600
v_add_u32 v2, 3584, v2
buffer_load_dwordx4 v2, s[48:51], 0 offen lds
s_add_u32 m0, m0, 3600
v_add_u32 v2, 3584, v2
buffer_load_dwordx4 v2, s[48:51], 0 offen lds
s_add_u32 m0, m0, 3600
v_add_u32 v2, 3584, v2
buffer_load_dwordx4 v2, s[48:51], 0 offen lds
s_add_u32 m0, m0, 3600
v_add_u32 v2, 3584, v2
buffer_load_dwordx4 v2, s[48:51], 0 offen lds
s_add_u32 m0, m0, 3600
v_add_u32 v2, 3584, v2
buffer_load_dwordx4 v2, s[48:51], 0 offen lds
s_add_u32 m0, m0, 3600
v_add_u32 v2, 3584, v2
buffer_load_dwordx4 v2, s[48:51], 0 offen lds
s_add_u32 m0, m0, 3600
v_add_u32 v2, 3584, v2
buffer_load_dwordx4 v2, s[48:51], 0 offen lds
s_add_u32 m0, m0, 3600
v_add_u32 v2, 3584, v2
buffer_load_dwordx4 v2, s[48:51], 0 offen lds
s_add_u32 m0, m0, 3600
v_add_u32 v2, 3584, v2
buffer_load_dwordx4 v2, s[48:51], 0 offen lds
s_add_u32 m0, m0, 3600
v_add_u32 v2, 3584, v2
buffer_load_dwordx4 v2, s[48:51], 0 offen lds
s_add_u32 m0, m0, 3600
v_add_u32 v2, 3584, v2
buffer_load_dwordx4 v2, s[48:51], 0 offen lds
s_add_u32 m0, m0, 3600
v_add_u32 v2, 3584, v2
buffer_load_dwordx4 v2, s[48:51], 0 offen lds
s_add_u32 m0, m0, 3600
v_add_u32 v2, 3584, v2
buffer_load_dwordx4 v2, s[48:51], 0 offen lds
s_add_u32 m0, m0, 3600
v_add_u32 v2, 3584, v2
buffer_load_dwordx4 v2, s[48:51], 0 offen lds
s_add_u32 m0, m0, 3600
v_add_u32 v2, 3584, v2
buffer_load_dwordx4 v2, s[48:51], 0 offen lds
s_add_u32 m0, m0, 3600
v_add_u32 v2, 3584, v2
s_cmp_eq_u32 s80, 3
s_cbranch_scc1 Lpk_20
buffer_load_dwordx4 v2, s[48:51], 0 offen lds
Lpk_20:
s_mul_i32 s5, s4, 896
s_add_u32 m0, s6, 60304
s_nop 0
s_nop 0
buffer_load_dwordx4 v1, s[56:59], s5 offen lds
s_add_u32 m0, m0, 3600
s_add_u32 s5, s5, 3584
buffer_load_dwordx4 v1, s[56:59], s5 offen lds
s_add_u32 m0, m0, 3600
s_add_u32 s5, s5, 3584
buffer_load_dwordx4 v1, s[56:59], s5 offen lds
s_add_u32 m0, m0, 3600
s_add_u32 s5, s5, 3584
buffer_load_dwordx4 v1, s[56:59], s5 offen lds
s_add_u32 m0, m0, 3600
s_add_u32 s5, s5, 3584
buffer_load_dwordx4 v1, s[56:59], s5 offen lds
s_add_u32 m0, m0, 3600
s_add_u32 s5, s5, 3584
buffer_load_dwordx4 v1, s[56:59], s5 offen lds
s_add_u32 m0, m0, 3600
s_add_u32 s5, s5, 3584
buffer_load_dwordx4 v1, s[56:59], s5 offen lds
s_add_u32 m0, m0, 3600
s_add_u32 s5, s5, 3584
buffer_load_dwordx4 v1, s[56:59], s5 offen lds
s_add_u32 m0, m0, 3600
s_add_u32 s5, s5, 3584
buffer_load_dwordx4 v1, s[56:59], s5 offen lds
s_add_u32 m0, m0, 3600
s_add_u32 s5, s5, 3584
buffer_load_dwordx4 v1, s[56:59], s5 offen lds
s_add_u32 m0, m0, 3600
s_add_u32 s5, s5, 3584
buffer_load_dwordx4 v1, s[56:59], s5 offen lds
s_add_u32 m0, m0, 3600
s_add_u32 s5, s5, 3584
buffer_load_dwordx4 v1, s[56:59], s5 offen lds
s_add_u32 m0, m0, 3600
s_add_u32 s5, s5, 3584
buffer_load_dwordx4 v1, s[56:59], s5 offen lds
s_add_u32 m0, m0, 3600
s_add_u32 s5, s5, 3584
buffer_load_dwordx4 v1, s[56:59], s5 offen lds
s_add_u32 m0, m0, 3600
s_add_u32 s5, s5, 3584
buffer_load_dwordx4 v1, s[56:59], s5 offen lds
s_add_u32 m0, m0, 3600
s_add_u32 s5, s5, 3584
buffer_load_dwordx4 v1, s[56:59], s5 offen lds
s_mov_b32 exec_hi, -1
s_mov_b32 s88, 0xffff0000
v_and_b32 v2, 3, v0
v_lshrrev_b32_e64 v3, 5, v0
v_lshl_add_u32 v2, v3, 2, v2
v_bfe_u32 v3, v0, 2, 3
v_mul_u32_u24 v4, 7200, v2
v_lshl_add_u32 v4, v3, 2, v4
s_lshl_b32 s4, s80, 5
v_add_u32 v4, s4, v4
v_add_u32 v8, 60304, v4
v_lshlrev_b32 v5, 4, v3
s_lshl_b32 s4, s80, 7
v_add_u32 v5, s4, v5
v_lshlrev_b32 v6, 13, v3
s_lshl_b32 s4, s80, 16
v_add_u32 v6, s4, v6
v_lshlrev_b32 v7, 4, v2
v_sub_u32 v6, v6, v7
s_lshl_b32 s4, s81, 7
s_sub_u32 s4, 7344112, s4
v_add_u32 v6, s4, v6
buffer_load_dwordx4 v[100:103], v5, s[60:63], 0 offen offset:0
buffer_load_dwordx4 v[104:107], v5, s[60:63], 0 offen offset:512
buffer_load_dwordx4 v[108:111], v5, s[60:63], 0 offen offset:1024
buffer_load_dwordx4 v[112:115], v5, s[60:63], 0 offen offset:1536
buffer_load_dwordx4 v[116:119], v5, s[60:63], 0 offen offset:2048
buffer_load_dwordx4 v[120:123], v5, s[60:63], 0 offen offset:2560
buffer_load_dwordx4 v[124:127], v5, s[60:63], 0 offen offset:3072
s_waitcnt vmcnt(0) lgkmcnt(0)
s_barrier
ds_read_b32 v16, v4 offset:0
ds_read_b32 v17, v4 offset:900
ds_read_b32 v18, v4 offset:1800
ds_read_b32 v19, v4 offset:2700
ds_read_b32 v20, v4 offset:3600
ds_read_b32 v21, v4 offset:4500
ds_read_b32 v22, v4 offset:5400
ds_read_b32 v23, v4 offset:6300
ds_read_b32 v24, v4 offset:7200
ds_read_b32 v25, v4 offset:8100
ds_read_b32 v26, v4 offset:9000
ds_read_b32 v27, v8 offset:0
ds_read_b32 v28, v8 offset:900
ds_read_b32 v29, v8 offset:1800
ds_read_b32 v30, v8 offset:2700
ds_read_b32 v31, v8 offset:3600
ds_read_b32 v32, v8 offset:4500
ds_read_b32 v33, v8 offset:5400
ds_read_b32 v34, v8 offset:6300
v_lshlrev_b32 v64, 16, v100
v_lshlrev_b32 v65, 16, v102
v_and_b32 v66, 0xffff0000, v100
v_and_b32 v67, 0xffff0000, v102
v_lshlrev_b32 v68, 16, v101
v_lshlrev_b32 v69, 16, v103
v_and_b32 v70, 0xffff0000, v101
v_and_b32 v71, 0xffff0000, v103
s_waitcnt lgkmcnt(0)
v_lshlrev_b32 v40, 16, v16
v_and_b32 v41, s88, v16
v_lshlrev_b32 v42, 16, v17
v_and_b32 v43, s88, v17
v_lshlrev_b32 v44, 16, v18
v_and_b32 v45, s88, v18
v_lshlrev_b32 v46, 16, v19
v_and_b32 v47, s88, v19
v_lshlrev_b32 v48, 16, v20
v_and_b32 v49, s88, v20
v_lshlrev_b32 v50, 16, v21
v_and_b32 v51, s88, v21
v_lshlrev_b32 v52, 16, v22
v_and_b32 v53, s88, v22
v_lshlrev_b32 v54, 16, v23
v_and_b32 v55, s88, v23
v_lshlrev_b32 v56, 16, v24
v_and_b32 v57, s88, v24
v_lshlrev_b32 v58, 16, v25
v_and_b32 v59, s88, v25
v_lshlrev_b32 v60, 16, v26
v_and_b32 v61, s88, v26
v_lshlrev_b32 v72, 16, v27
v_and_b32 v73, s88, v27
v_lshlrev_b32 v74, 16, v28
v_and_b32 v75, s88, v28
v_lshlrev_b32 v76, 16, v29
v_and_b32 v77, s88, v29
v_lshlrev_b32 v78, 16, v30
v_and_b32 v79, s88, v30
v_lshlrev_b32 v80, 16, v31
v_and_b32 v81, s88, v31
v_lshlrev_b32 v82, 16, v32
v_and_b32 v83, s88, v32
v_lshlrev_b32 v84, 16, v33
v_and_b32 v85, s88, v33
v_lshlrev_b32 v86, 16, v34
v_and_b32_e64 v87, s88, v34
ds_read_b32 v176, v4 offset:128
ds_read_b32 v177, v4 offset:1028
ds_read_b32 v178, v4 offset:1928
ds_read_b32 v179, v4 offset:2828
ds_read_b32 v180, v4 offset:3728
ds_read_b32 v181, v4 offset:4628
ds_read_b32 v182, v4 offset:5528
ds_read_b32 v183, v4 offset:6428
ds_read_b32 v184, v4 offset:7328
ds_read_b32 v185, v4 offset:8228
ds_read_b32 v186, v4 offset:9128
ds_read_b32 v187, v8 offset:128
ds_read_b32 v188, v8 offset:1028
ds_read_b32 v189, v8 offset:1928
ds_read_b32 v190, v8 offset:2828
ds_read_b32 v191, v8 offset:3728
ds_read_b32 v192, v8 offset:4628
ds_read_b32 v193, v8 offset:5528
ds_read_b32 v194, v8 offset:6428
v_pk_mul_f32 v[130:131], v[46:47], v[64:65]
v_pk_mul_f32 v[132:133], v[48:49], v[64:65]
v_pk_mul_f32 v[134:135], v[50:51], v[64:65]
v_pk_mul_f32 v[136:137], v[52:53], v[64:65]
v_pk_mul_f32 v[138:139], v[54:55], v[64:65]
v_pk_mul_f32 v[140:141], v[56:57], v[64:65]
v_pk_mul_f32 v[142:143], v[58:59], v[64:65]
v_pk_mul_f32 v[144:145], v[60:61], v[64:65]
v_pk_fma_f32 v[130:131], v[44:45], v[66:67], v[130:131]
v_pk_fma_f32 v[132:133], v[46:47], v[66:67], v[132:133]
v_pk_fma_f32 v[134:135], v[48:49], v[66:67], v[134:135]
v_pk_fma_f32 v[136:137], v[50:51], v[66:67], v[136:137]
v_pk_fma_f32 v[138:139], v[52:53], v[66:67], v[138:139]
v_pk_fma_f32 v[140:141], v[54:55], v[66:67], v[140:141]
v_pk_fma_f32 v[142:143], v[56:57], v[66:67], v[142:143]
v_pk_fma_f32 v[144:145], v[58:59], v[66:67], v[144:145]
v_pk_fma_f32 v[130:131], v[42:43], v[68:69], v[130:131]
v_pk_fma_f32 v[132:133], v[44:45], v[68:69], v[132:133]
v_pk_fma_f32 v[134:135], v[46:47], v[68:69], v[134:135]
v_pk_fma_f32 v[136:137], v[48:49], v[68:69], v[136:137]
v_pk_fma_f32 v[138:139], v[50:51], v[68:69], v[138:139]
v_pk_fma_f32 v[140:141], v[52:53], v[68:69], v[140:141]
v_pk_fma_f32 v[142:143], v[54:55], v[68:69], v[142:143]
v_pk_fma_f32 v[144:145], v[56:57], v[68:69], v[144:145]
v_pk_fma_f32 v[130:131], v[40:41], v[70:71], v[130:131]
v_pk_fma_f32 v[132:133], v[42:43], v[70:71], v[132:133]
v_pk_fma_f32 v[134:135], v[44:45], v[70:71], v[134:135]
v_pk_fma_f32 v[136:137], v[46:47], v[70:71], v[136:137]
v_pk_fma_f32 v[138:139], v[48:49], v[70:71], v[138:139]
v_pk_fma_f32 v[140:141], v[50:51], v[70:71], v[140:141]
v_pk_fma_f32 v[142:143], v[52:53], v[70:71], v[142:143]
v_pk_fma_f32 v[144:145], v[54:55], v[70:71], v[144:145]
v_pk_mul_f32 v[130:131], v[130:131], v[72:73]
v_pk_mul_f32 v[132:133], v[132:133], v[74:75]
v_pk_mul_f32 v[134:135], v[134:135], v[76:77]
v_pk_mul_f32 v[136:137], v[136:137], v[78:79]
v_pk_mul_f32 v[138:139], v[138:139], v[80:81]
v_pk_mul_f32 v[140:141], v[140:141], v[82:83]
v_pk_mul_f32 v[142:143], v[142:143], v[84:85]
v_pk_mul_f32 v[144:145], v[144:145], v[86:87]
v_cvt_pk_bf16_f32 v150, v144, v142
v_cvt_pk_bf16_f32 v154, v145, v143
v_cvt_pk_bf16_f32 v151, v140, v138
v_cvt_pk_bf16_f32 v155, v141, v139
v_cvt_pk_bf16_f32 v152, v136, v134
v_cvt_pk_bf16_f32 v156, v137, v135
v_cvt_pk_bf16_f32 v153, v132, v130
v_cvt_pk_bf16_f32 v157, v133, v131
s_mov_b32 s4, 0
s_mov_b32 s5, 4096
buffer_store_dwordx4 v[150:153], v6, s[52:55], s4 offen sc1
buffer_store_dwordx4 v[154:157], v6, s[52:55], s5 offen sc1
v_lshlrev_b32 v64, 16, v104
v_lshlrev_b32_e64 v65, 16, v106
v_and_b32 v66, 0xffff0000, v104
v_and_b32 v67, 0xffff0000, v106
v_lshlrev_b32 v68, 16, v105
v_lshlrev_b32 v69, 16, v107
v_and_b32 v70, 0xffff0000, v105
v_and_b32 v71, 0xffff0000, v107
s_waitcnt lgkmcnt(0)
v_lshlrev_b32 v40, 16, v176
v_and_b32 v41, s88, v176
v_lshlrev_b32 v42, 16, v177
v_and_b32 v43, s88, v177
v_lshlrev_b32 v44, 16, v178
v_and_b32 v45, s88, v178
v_lshlrev_b32 v46, 16, v179
v_and_b32 v47, s88, v179
v_lshlrev_b32 v48, 16, v180
v_and_b32 v49, s88, v180
v_lshlrev_b32 v50, 16, v181
v_and_b32 v51, s88, v181
v_lshlrev_b32 v52, 16, v182
v_and_b32 v53, s88, v182
v_lshlrev_b32 v54, 16, v183
v_and_b32 v55, s88, v183
v_lshlrev_b32 v56, 16, v184
v_and_b32 v57, s88, v184
v_lshlrev_b32 v58, 16, v185
v_and_b32 v59, s88, v185
v_lshlrev_b32 v60, 16, v186
v_and_b32 v61, s88, v186
v_lshlrev_b32 v72, 16, v187
v_and_b32 v73, s88, v187
v_lshlrev_b32 v74, 16, v188
v_and_b32 v75, s88, v188
v_lshlrev_b32 v76, 16, v189
v_and_b32 v77, s88, v189
v_lshlrev_b32 v78, 16, v190
v_and_b32 v79, s88, v190
v_lshlrev_b32 v80, 16, v191
v_and_b32 v81, s88, v191
v_lshlrev_b32 v82, 16, v192
v_and_b32 v83, s88, v192
v_lshlrev_b32 v84, 16, v193
v_and_b32 v85, s88, v193
v_lshlrev_b32 v86, 16, v194
v_and_b32_e64 v87, s88, v194
ds_read_b32 v16, v4 offset:256
ds_read_b32 v17, v4 offset:1156
ds_read_b32 v18, v4 offset:2056
ds_read_b32 v19, v4 offset:2956
ds_read_b32 v20, v4 offset:3856
ds_read_b32 v21, v4 offset:4756
ds_read_b32 v22, v4 offset:5656
ds_read_b32 v23, v4 offset:6556
ds_read_b32 v24, v4 offset:7456
ds_read_b32 v25, v4 offset:8356
ds_read_b32 v26, v4 offset:9256
ds_read_b32 v27, v8 offset:256
ds_read_b32 v28, v8 offset:1156
ds_read_b32 v29, v8 offset:2056
ds_read_b32 v30, v8 offset:2956
ds_read_b32 v31, v8 offset:3856
ds_read_b32 v32, v8 offset:4756
ds_read_b32 v33, v8 offset:5656
ds_read_b32 v34, v8 offset:6556
v_pk_mul_f32 v[130:131], v[46:47], v[64:65]
v_pk_mul_f32 v[132:133], v[48:49], v[64:65]
v_pk_mul_f32 v[134:135], v[50:51], v[64:65]
v_pk_mul_f32 v[136:137], v[52:53], v[64:65]
v_pk_mul_f32 v[138:139], v[54:55], v[64:65]
v_pk_mul_f32 v[140:141], v[56:57], v[64:65]
v_pk_mul_f32 v[142:143], v[58:59], v[64:65]
v_pk_mul_f32 v[144:145], v[60:61], v[64:65]
v_pk_fma_f32 v[130:131], v[44:45], v[66:67], v[130:131]
v_pk_fma_f32 v[132:133], v[46:47], v[66:67], v[132:133]
v_pk_fma_f32 v[134:135], v[48:49], v[66:67], v[134:135]
v_pk_fma_f32 v[136:137], v[50:51], v[66:67], v[136:137]
v_pk_fma_f32 v[138:139], v[52:53], v[66:67], v[138:139]
v_pk_fma_f32 v[140:141], v[54:55], v[66:67], v[140:141]
v_pk_fma_f32 v[142:143], v[56:57], v[66:67], v[142:143]
v_pk_fma_f32 v[144:145], v[58:59], v[66:67], v[144:145]
v_pk_fma_f32 v[130:131], v[42:43], v[68:69], v[130:131]
v_pk_fma_f32 v[132:133], v[44:45], v[68:69], v[132:133]
v_pk_fma_f32 v[134:135], v[46:47], v[68:69], v[134:135]
v_pk_fma_f32 v[136:137], v[48:49], v[68:69], v[136:137]
v_pk_fma_f32 v[138:139], v[50:51], v[68:69], v[138:139]
v_pk_fma_f32 v[140:141], v[52:53], v[68:69], v[140:141]
v_pk_fma_f32 v[142:143], v[54:55], v[68:69], v[142:143]
v_pk_fma_f32 v[144:145], v[56:57], v[68:69], v[144:145]
v_pk_fma_f32 v[130:131], v[40:41], v[70:71], v[130:131]
v_pk_fma_f32 v[132:133], v[42:43], v[70:71], v[132:133]
v_pk_fma_f32 v[134:135], v[44:45], v[70:71], v[134:135]
v_pk_fma_f32 v[136:137], v[46:47], v[70:71], v[136:137]
v_pk_fma_f32 v[138:139], v[48:49], v[70:71], v[138:139]
v_pk_fma_f32 v[140:141], v[50:51], v[70:71], v[140:141]
v_pk_fma_f32 v[142:143], v[52:53], v[70:71], v[142:143]
v_pk_fma_f32 v[144:145], v[54:55], v[70:71], v[144:145]
v_pk_mul_f32 v[130:131], v[130:131], v[72:73]
v_pk_mul_f32 v[132:133], v[132:133], v[74:75]
v_pk_mul_f32 v[134:135], v[134:135], v[76:77]
v_pk_mul_f32 v[136:137], v[136:137], v[78:79]
v_pk_mul_f32 v[138:139], v[138:139], v[80:81]
v_pk_mul_f32 v[140:141], v[140:141], v[82:83]
v_pk_mul_f32 v[142:143], v[142:143], v[84:85]
v_pk_mul_f32 v[144:145], v[144:145], v[86:87]
v_cvt_pk_bf16_f32 v158, v144, v142
v_cvt_pk_bf16_f32 v162, v145, v143
v_cvt_pk_bf16_f32 v159, v140, v138
v_cvt_pk_bf16_f32 v163, v141, v139
v_cvt_pk_bf16_f32 v160, v136, v134
v_cvt_pk_bf16_f32 v164, v137, v135
v_cvt_pk_bf16_f32 v161, v132, v130
v_cvt_pk_bf16_f32 v165, v133, v131
s_mov_b32 s4, 262144
s_mov_b32 s5, 266240
buffer_store_dwordx4 v[158:161], v6, s[52:55], s4 offen sc1
buffer_store_dwordx4 v[162:165], v6, s[52:55], s5 offen sc1
v_lshlrev_b32 v64, 16, v108
v_lshlrev_b32 v65, 16, v110
v_and_b32 v66, 0xffff0000, v108
v_and_b32 v67, 0xffff0000, v110
v_lshlrev_b32 v68, 16, v109
v_lshlrev_b32 v69, 16, v111
v_and_b32 v70, 0xffff0000, v109
v_and_b32 v71, 0xffff0000, v111
s_waitcnt lgkmcnt(0)
v_lshlrev_b32 v40, 16, v16
v_and_b32 v41, s88, v16
v_lshlrev_b32 v42, 16, v17
v_and_b32 v43, s88, v17
v_lshlrev_b32 v44, 16, v18
v_and_b32 v45, s88, v18
v_lshlrev_b32 v46, 16, v19
v_and_b32 v47, s88, v19
v_lshlrev_b32 v48, 16, v20
v_and_b32 v49, s88, v20
v_lshlrev_b32 v50, 16, v21
v_and_b32 v51, s88, v21
v_lshlrev_b32 v52, 16, v22
v_and_b32 v53, s88, v22
v_lshlrev_b32 v54, 16, v23
v_and_b32 v55, s88, v23
v_lshlrev_b32 v56, 16, v24
v_and_b32 v57, s88, v24
v_lshlrev_b32 v58, 16, v25
v_and_b32 v59, s88, v25
v_lshlrev_b32 v60, 16, v26
v_and_b32 v61, s88, v26
v_lshlrev_b32 v72, 16, v27
v_and_b32 v73, s88, v27
v_lshlrev_b32 v74, 16, v28
v_and_b32 v75, s88, v28
v_lshlrev_b32 v76, 16, v29
v_and_b32 v77, s88, v29
v_lshlrev_b32 v78, 16, v30
v_and_b32 v79, s88, v30
v_lshlrev_b32 v80, 16, v31
v_and_b32 v81, s88, v31
v_lshlrev_b32 v82, 16, v32
v_and_b32 v83, s88, v32
v_lshlrev_b32 v84, 16, v33
v_and_b32 v85, s88, v33
v_lshlrev_b32 v86, 16, v34
v_and_b32_e64 v87, s88, v34
ds_read_b32 v176, v4 offset:384
ds_read_b32 v177, v4 offset:1284
ds_read_b32 v178, v4 offset:2184
ds_read_b32 v179, v4 offset:3084
ds_read_b32 v180, v4 offset:3984
ds_read_b32 v181, v4 offset:4884
ds_read_b32 v182, v4 offset:5784
ds_read_b32 v183, v4 offset:6684
ds_read_b32 v184, v4 offset:7584
ds_read_b32 v185, v4 offset:8484
ds_read_b32 v186, v4 offset:9384
ds_read_b32 v187, v8 offset:384
ds_read_b32 v188, v8 offset:1284
ds_read_b32 v189, v8 offset:2184
ds_read_b32 v190, v8 offset:3084
ds_read_b32 v191, v8 offset:3984
ds_read_b32 v192, v8 offset:4884
ds_read_b32 v193, v8 offset:5784
ds_read_b32 v194, v8 offset:6684
v_pk_mul_f32 v[130:131], v[46:47], v[64:65]
v_pk_mul_f32 v[132:133], v[48:49], v[64:65]
v_pk_mul_f32 v[134:135], v[50:51], v[64:65]
v_pk_mul_f32 v[136:137], v[52:53], v[64:65]
v_pk_mul_f32 v[138:139], v[54:55], v[64:65]
v_pk_mul_f32 v[140:141], v[56:57], v[64:65]
v_pk_mul_f32 v[142:143], v[58:59], v[64:65]
v_pk_mul_f32 v[144:145], v[60:61], v[64:65]
v_pk_fma_f32 v[130:131], v[44:45], v[66:67], v[130:131]
v_pk_fma_f32 v[132:133], v[46:47], v[66:67], v[132:133]
v_pk_fma_f32 v[134:135], v[48:49], v[66:67], v[134:135]
v_pk_fma_f32 v[136:137], v[50:51], v[66:67], v[136:137]
v_pk_fma_f32 v[138:139], v[52:53], v[66:67], v[138:139]
v_pk_fma_f32 v[140:141], v[54:55], v[66:67], v[140:141]
v_pk_fma_f32 v[142:143], v[56:57], v[66:67], v[142:143]
v_pk_fma_f32 v[144:145], v[58:59], v[66:67], v[144:145]
v_pk_fma_f32 v[130:131], v[42:43], v[68:69], v[130:131]
v_pk_fma_f32 v[132:133], v[44:45], v[68:69], v[132:133]
v_pk_fma_f32 v[134:135], v[46:47], v[68:69], v[134:135]
v_pk_fma_f32 v[136:137], v[48:49], v[68:69], v[136:137]
v_pk_fma_f32 v[138:139], v[50:51], v[68:69], v[138:139]
v_pk_fma_f32 v[140:141], v[52:53], v[68:69], v[140:141]
v_pk_fma_f32 v[142:143], v[54:55], v[68:69], v[142:143]
v_pk_fma_f32 v[144:145], v[56:57], v[68:69], v[144:145]
v_pk_fma_f32 v[130:131], v[40:41], v[70:71], v[130:131]
v_pk_fma_f32 v[132:133], v[42:43], v[70:71], v[132:133]
v_pk_fma_f32 v[134:135], v[44:45], v[70:71], v[134:135]
v_pk_fma_f32 v[136:137], v[46:47], v[70:71], v[136:137]
v_pk_fma_f32 v[138:139], v[48:49], v[70:71], v[138:139]
v_pk_fma_f32 v[140:141], v[50:51], v[70:71], v[140:141]
v_pk_fma_f32 v[142:143], v[52:53], v[70:71], v[142:143]
v_pk_fma_f32 v[144:145], v[54:55], v[70:71], v[144:145]
v_pk_mul_f32 v[130:131], v[130:131], v[72:73]
v_pk_mul_f32 v[132:133], v[132:133], v[74:75]
v_pk_mul_f32 v[134:135], v[134:135], v[76:77]
v_pk_mul_f32 v[136:137], v[136:137], v[78:79]
v_pk_mul_f32 v[138:139], v[138:139], v[80:81]
v_pk_mul_f32 v[140:141], v[140:141], v[82:83]
v_pk_mul_f32 v[142:143], v[142:143], v[84:85]
v_pk_mul_f32 v[144:145], v[144:145], v[86:87]
v_cvt_pk_bf16_f32 v150, v144, v142
v_cvt_pk_bf16_f32 v154, v145, v143
v_cvt_pk_bf16_f32 v151, v140, v138
v_cvt_pk_bf16_f32 v155, v141, v139
v_cvt_pk_bf16_f32 v152, v136, v134
v_cvt_pk_bf16_f32 v156, v137, v135
v_cvt_pk_bf16_f32 v153, v132, v130
v_cvt_pk_bf16_f32 v157, v133, v131
s_mov_b32 s4, 524288
s_mov_b32 s5, 528384
buffer_store_dwordx4 v[150:153], v6, s[52:55], s4 offen sc1
buffer_store_dwordx4 v[154:157], v6, s[52:55], s5 offen sc1
v_lshlrev_b32 v64, 16, v112
v_lshlrev_b32 v65, 16, v114
v_and_b32 v66, 0xffff0000, v112
v_and_b32 v67, 0xffff0000, v114
v_lshlrev_b32 v68, 16, v113
v_lshlrev_b32 v69, 16, v115
v_and_b32 v70, 0xffff0000, v113
v_and_b32 v71, 0xffff0000, v115
s_waitcnt lgkmcnt(0)
v_lshlrev_b32 v40, 16, v176
v_and_b32 v41, s88, v176
v_lshlrev_b32 v42, 16, v177
v_and_b32 v43, s88, v177
v_lshlrev_b32 v44, 16, v178
v_and_b32 v45, s88, v178
v_lshlrev_b32 v46, 16, v179
v_and_b32 v47, s88, v179
v_lshlrev_b32 v48, 16, v180
v_and_b32 v49, s88, v180
v_lshlrev_b32 v50, 16, v181
v_and_b32 v51, s88, v181
v_lshlrev_b32 v52, 16, v182
v_and_b32 v53, s88, v182
v_lshlrev_b32 v54, 16, v183
v_and_b32 v55, s88, v183
v_lshlrev_b32 v56, 16, v184
v_and_b32 v57, s88, v184
v_lshlrev_b32 v58, 16, v185
v_and_b32 v59, s88, v185
v_lshlrev_b32 v60, 16, v186
v_and_b32 v61, s88, v186
v_lshlrev_b32 v72, 16, v187
v_and_b32 v73, s88, v187
v_lshlrev_b32 v74, 16, v188
v_and_b32 v75, s88, v188
v_lshlrev_b32 v76, 16, v189
v_and_b32 v77, s88, v189
v_lshlrev_b32 v78, 16, v190
v_and_b32 v79, s88, v190
v_lshlrev_b32 v80, 16, v191
v_and_b32 v81, s88, v191
v_lshlrev_b32 v82, 16, v192
v_and_b32 v83, s88, v192
v_lshlrev_b32 v84, 16, v193
v_and_b32 v85, s88, v193
v_lshlrev_b32 v86, 16, v194
v_and_b32_e64 v87, s88, v194
ds_read_b32 v16, v4 offset:512
ds_read_b32 v17, v4 offset:1412
ds_read_b32 v18, v4 offset:2312
ds_read_b32 v19, v4 offset:3212
ds_read_b32 v20, v4 offset:4112
ds_read_b32 v21, v4 offset:5012
ds_read_b32 v22, v4 offset:5912
ds_read_b32 v23, v4 offset:6812
ds_read_b32 v24, v4 offset:7712
ds_read_b32 v25, v4 offset:8612
ds_read_b32 v26, v4 offset:9512
ds_read_b32 v27, v8 offset:512
ds_read_b32 v28, v8 offset:1412
ds_read_b32 v29, v8 offset:2312
ds_read_b32 v30, v8 offset:3212
ds_read_b32 v31, v8 offset:4112
ds_read_b32 v32, v8 offset:5012
ds_read_b32 v33, v8 offset:5912
ds_read_b32 v34, v8 offset:6812
v_pk_mul_f32 v[130:131], v[46:47], v[64:65]
v_pk_mul_f32 v[132:133], v[48:49], v[64:65]
v_pk_mul_f32 v[134:135], v[50:51], v[64:65]
v_pk_mul_f32 v[136:137], v[52:53], v[64:65]
v_pk_mul_f32 v[138:139], v[54:55], v[64:65]
v_pk_mul_f32 v[140:141], v[56:57], v[64:65]
v_pk_mul_f32 v[142:143], v[58:59], v[64:65]
v_pk_mul_f32 v[144:145], v[60:61], v[64:65]
v_pk_fma_f32 v[130:131], v[44:45], v[66:67], v[130:131]
v_pk_fma_f32 v[132:133], v[46:47], v[66:67], v[132:133]
v_pk_fma_f32 v[134:135], v[48:49], v[66:67], v[134:135]
v_pk_fma_f32 v[136:137], v[50:51], v[66:67], v[136:137]
v_pk_fma_f32 v[138:139], v[52:53], v[66:67], v[138:139]
v_pk_fma_f32 v[140:141], v[54:55], v[66:67], v[140:141]
v_pk_fma_f32 v[142:143], v[56:57], v[66:67], v[142:143]
v_pk_fma_f32 v[144:145], v[58:59], v[66:67], v[144:145]
v_pk_fma_f32 v[130:131], v[42:43], v[68:69], v[130:131]
v_pk_fma_f32 v[132:133], v[44:45], v[68:69], v[132:133]
v_pk_fma_f32 v[134:135], v[46:47], v[68:69], v[134:135]
v_pk_fma_f32 v[136:137], v[48:49], v[68:69], v[136:137]
v_pk_fma_f32 v[138:139], v[50:51], v[68:69], v[138:139]
v_pk_fma_f32 v[140:141], v[52:53], v[68:69], v[140:141]
v_pk_fma_f32 v[142:143], v[54:55], v[68:69], v[142:143]
v_pk_fma_f32 v[144:145], v[56:57], v[68:69], v[144:145]
v_pk_fma_f32 v[130:131], v[40:41], v[70:71], v[130:131]
v_pk_fma_f32 v[132:133], v[42:43], v[70:71], v[132:133]
v_pk_fma_f32 v[134:135], v[44:45], v[70:71], v[134:135]
v_pk_fma_f32 v[136:137], v[46:47], v[70:71], v[136:137]
v_pk_fma_f32 v[138:139], v[48:49], v[70:71], v[138:139]
v_pk_fma_f32 v[140:141], v[50:51], v[70:71], v[140:141]
v_pk_fma_f32 v[142:143], v[52:53], v[70:71], v[142:143]
v_pk_fma_f32 v[144:145], v[54:55], v[70:71], v[144:145]
v_pk_mul_f32 v[130:131], v[130:131], v[72:73]
v_pk_mul_f32 v[132:133], v[132:133], v[74:75]
v_pk_mul_f32 v[134:135], v[134:135], v[76:77]
v_pk_mul_f32 v[136:137], v[136:137], v[78:79]
v_pk_mul_f32 v[138:139], v[138:139], v[80:81]
v_pk_mul_f32 v[140:141], v[140:141], v[82:83]
v_pk_mul_f32 v[142:143], v[142:143], v[84:85]
v_pk_mul_f32 v[144:145], v[144:145], v[86:87]
v_cvt_pk_bf16_f32 v158, v144, v142
v_cvt_pk_bf16_f32 v162, v145, v143
v_cvt_pk_bf16_f32 v159, v140, v138
v_cvt_pk_bf16_f32 v163, v141, v139
v_cvt_pk_bf16_f32 v160, v136, v134
v_cvt_pk_bf16_f32 v164, v137, v135
v_cvt_pk_bf16_f32 v161, v132, v130
v_cvt_pk_bf16_f32 v165, v133, v131
s_mov_b32 s4, 786432
s_mov_b32 s5, 790528
buffer_store_dwordx4 v[158:161], v6, s[52:55], s4 offen sc1
buffer_store_dwordx4 v[162:165], v6, s[52:55], s5 offen sc1
v_lshlrev_b32 v64, 16, v116
v_lshlrev_b32 v65, 16, v118
v_and_b32 v66, 0xffff0000, v116
v_and_b32 v67, 0xffff0000, v118
v_lshlrev_b32 v68, 16, v117
v_lshlrev_b32 v69, 16, v119
v_and_b32 v70, 0xffff0000, v117
v_and_b32 v71, 0xffff0000, v119
s_waitcnt lgkmcnt(0)
v_lshlrev_b32 v40, 16, v16
v_and_b32 v41, s88, v16
v_lshlrev_b32 v42, 16, v17
v_and_b32 v43, s88, v17
v_lshlrev_b32 v44, 16, v18
v_and_b32 v45, s88, v18
v_lshlrev_b32 v46, 16, v19
v_and_b32 v47, s88, v19
v_lshlrev_b32 v48, 16, v20
v_and_b32 v49, s88, v20
v_lshlrev_b32 v50, 16, v21
v_and_b32 v51, s88, v21
v_lshlrev_b32 v52, 16, v22
v_and_b32 v53, s88, v22
v_lshlrev_b32 v54, 16, v23
v_and_b32 v55, s88, v23
v_lshlrev_b32 v56, 16, v24
v_and_b32 v57, s88, v24
v_lshlrev_b32 v58, 16, v25
v_and_b32 v59, s88, v25
v_lshlrev_b32 v60, 16, v26
v_and_b32 v61, s88, v26
v_lshlrev_b32 v72, 16, v27
v_and_b32 v73, s88, v27
v_lshlrev_b32 v74, 16, v28
v_and_b32 v75, s88, v28
v_lshlrev_b32 v76, 16, v29
v_and_b32 v77, s88, v29
v_lshlrev_b32 v78, 16, v30
v_and_b32 v79, s88, v30
v_lshlrev_b32 v80, 16, v31
v_and_b32 v81, s88, v31
v_lshlrev_b32 v82, 16, v32
v_and_b32 v83, s88, v32
v_lshlrev_b32 v84, 16, v33
v_and_b32 v85, s88, v33
v_lshlrev_b32 v86, 16, v34
v_and_b32_e64 v87, s88, v34
ds_read_b32 v176, v4 offset:640
ds_read_b32 v177, v4 offset:1540
ds_read_b32 v178, v4 offset:2440
ds_read_b32 v179, v4 offset:3340
ds_read_b32 v180, v4 offset:4240
ds_read_b32 v181, v4 offset:5140
ds_read_b32 v182, v4 offset:6040
ds_read_b32 v183, v4 offset:6940
ds_read_b32 v184, v4 offset:7840
ds_read_b32 v185, v4 offset:8740
ds_read_b32 v186, v4 offset:9640
ds_read_b32 v187, v8 offset:640
ds_read_b32 v188, v8 offset:1540
ds_read_b32 v189, v8 offset:2440
ds_read_b32 v190, v8 offset:3340
ds_read_b32 v191, v8 offset:4240
ds_read_b32 v192, v8 offset:5140
ds_read_b32 v193, v8 offset:6040
ds_read_b32 v194, v8 offset:6940
v_pk_mul_f32 v[130:131], v[46:47], v[64:65]
v_pk_mul_f32 v[132:133], v[48:49], v[64:65]
v_pk_mul_f32 v[134:135], v[50:51], v[64:65]
v_pk_mul_f32 v[136:137], v[52:53], v[64:65]
v_pk_mul_f32 v[138:139], v[54:55], v[64:65]
v_pk_mul_f32 v[140:141], v[56:57], v[64:65]
v_pk_mul_f32 v[142:143], v[58:59], v[64:65]
v_pk_mul_f32 v[144:145], v[60:61], v[64:65]
v_pk_fma_f32 v[130:131], v[44:45], v[66:67], v[130:131]
v_pk_fma_f32 v[132:133], v[46:47], v[66:67], v[132:133]
v_pk_fma_f32 v[134:135], v[48:49], v[66:67], v[134:135]
v_pk_fma_f32 v[136:137], v[50:51], v[66:67], v[136:137]
v_pk_fma_f32 v[138:139], v[52:53], v[66:67], v[138:139]
v_pk_fma_f32 v[140:141], v[54:55], v[66:67], v[140:141]
v_pk_fma_f32 v[142:143], v[56:57], v[66:67], v[142:143]
v_pk_fma_f32 v[144:145], v[58:59], v[66:67], v[144:145]
v_pk_fma_f32 v[130:131], v[42:43], v[68:69], v[130:131]
v_pk_fma_f32 v[132:133], v[44:45], v[68:69], v[132:133]
v_pk_fma_f32 v[134:135], v[46:47], v[68:69], v[134:135]
v_pk_fma_f32 v[136:137], v[48:49], v[68:69], v[136:137]
v_pk_fma_f32 v[138:139], v[50:51], v[68:69], v[138:139]
v_pk_fma_f32 v[140:141], v[52:53], v[68:69], v[140:141]
v_pk_fma_f32 v[142:143], v[54:55], v[68:69], v[142:143]
v_pk_fma_f32 v[144:145], v[56:57], v[68:69], v[144:145]
v_pk_fma_f32 v[130:131], v[40:41], v[70:71], v[130:131]
v_pk_fma_f32 v[132:133], v[42:43], v[70:71], v[132:133]
v_pk_fma_f32 v[134:135], v[44:45], v[70:71], v[134:135]
v_pk_fma_f32 v[136:137], v[46:47], v[70:71], v[136:137]
v_pk_fma_f32 v[138:139], v[48:49], v[70:71], v[138:139]
v_pk_fma_f32 v[140:141], v[50:51], v[70:71], v[140:141]
v_pk_fma_f32 v[142:143], v[52:53], v[70:71], v[142:143]
v_pk_fma_f32 v[144:145], v[54:55], v[70:71], v[144:145]
v_pk_mul_f32 v[130:131], v[130:131], v[72:73]
v_pk_mul_f32 v[132:133], v[132:133], v[74:75]
v_pk_mul_f32 v[134:135], v[134:135], v[76:77]
v_pk_mul_f32 v[136:137], v[136:137], v[78:79]
v_pk_mul_f32 v[138:139], v[138:139], v[80:81]
v_pk_mul_f32 v[140:141], v[140:141], v[82:83]
v_pk_mul_f32 v[142:143], v[142:143], v[84:85]
v_pk_mul_f32 v[144:145], v[144:145], v[86:87]
v_cvt_pk_bf16_f32 v150, v144, v142
v_cvt_pk_bf16_f32 v154, v145, v143
v_cvt_pk_bf16_f32 v151, v140, v138
v_cvt_pk_bf16_f32 v155, v141, v139
v_cvt_pk_bf16_f32 v152, v136, v134
v_cvt_pk_bf16_f32 v156, v137, v135
v_cvt_pk_bf16_f32 v153, v132, v130
v_cvt_pk_bf16_f32 v157, v133, v131
s_mov_b32 s4, 1048576
s_mov_b32 s5, 1052672
buffer_store_dwordx4 v[150:153], v6, s[52:55], s4 offen sc1
buffer_store_dwordx4 v[154:157], v6, s[52:55], s5 offen sc1
v_lshlrev_b32 v64, 16, v120
v_lshlrev_b32 v65, 16, v122
v_and_b32 v66, 0xffff0000, v120
v_and_b32 v67, 0xffff0000, v122
v_lshlrev_b32 v68, 16, v121
v_lshlrev_b32 v69, 16, v123
v_and_b32 v70, 0xffff0000, v121
v_and_b32 v71, 0xffff0000, v123
s_waitcnt lgkmcnt(0)
v_lshlrev_b32 v40, 16, v176
v_and_b32 v41, s88, v176
v_lshlrev_b32 v42, 16, v177
v_and_b32 v43, s88, v177
v_lshlrev_b32 v44, 16, v178
v_and_b32 v45, s88, v178
v_lshlrev_b32 v46, 16, v179
v_and_b32 v47, s88, v179
v_lshlrev_b32 v48, 16, v180
v_and_b32 v49, s88, v180
v_lshlrev_b32 v50, 16, v181
v_and_b32 v51, s88, v181
v_lshlrev_b32 v52, 16, v182
v_and_b32 v53, s88, v182
v_lshlrev_b32 v54, 16, v183
v_and_b32 v55, s88, v183
v_lshlrev_b32 v56, 16, v184
v_and_b32 v57, s88, v184
v_lshlrev_b32 v58, 16, v185
v_and_b32 v59, s88, v185
v_lshlrev_b32 v60, 16, v186
v_and_b32 v61, s88, v186
v_lshlrev_b32 v72, 16, v187
v_and_b32 v73, s88, v187
v_lshlrev_b32 v74, 16, v188
v_and_b32 v75, s88, v188
v_lshlrev_b32 v76, 16, v189
v_and_b32 v77, s88, v189
v_lshlrev_b32 v78, 16, v190
v_and_b32 v79, s88, v190
v_lshlrev_b32 v80, 16, v191
v_and_b32 v81, s88, v191
v_lshlrev_b32 v82, 16, v192
v_and_b32 v83, s88, v192
v_lshlrev_b32 v84, 16, v193
v_and_b32 v85, s88, v193
v_lshlrev_b32 v86, 16, v194
v_and_b32_e64 v87, s88, v194
ds_read_b32 v16, v4 offset:768
ds_read_b32 v17, v4 offset:1668
ds_read_b32 v18, v4 offset:2568
ds_read_b32 v19, v4 offset:3468
ds_read_b32 v20, v4 offset:4368
ds_read_b32 v21, v4 offset:5268
ds_read_b32 v22, v4 offset:6168
ds_read_b32 v23, v4 offset:7068
ds_read_b32 v24, v4 offset:7968
ds_read_b32 v25, v4 offset:8868
ds_read_b32 v26, v4 offset:9768
ds_read_b32 v27, v8 offset:768
ds_read_b32 v28, v8 offset:1668
ds_read_b32 v29, v8 offset:2568
ds_read_b32 v30, v8 offset:3468
ds_read_b32 v31, v8 offset:4368
ds_read_b32 v32, v8 offset:5268
ds_read_b32 v33, v8 offset:6168
ds_read_b32 v34, v8 offset:7068
v_pk_mul_f32 v[130:131], v[46:47], v[64:65]
v_pk_mul_f32 v[132:133], v[48:49], v[64:65]
v_pk_mul_f32 v[134:135], v[50:51], v[64:65]
v_pk_mul_f32 v[136:137], v[52:53], v[64:65]
v_pk_mul_f32 v[138:139], v[54:55], v[64:65]
v_pk_mul_f32 v[140:141], v[56:57], v[64:65]
v_pk_mul_f32 v[142:143], v[58:59], v[64:65]
v_pk_mul_f32 v[144:145], v[60:61], v[64:65]
v_pk_fma_f32 v[130:131], v[44:45], v[66:67], v[130:131]
v_pk_fma_f32 v[132:133], v[46:47], v[66:67], v[132:133]
v_pk_fma_f32 v[134:135], v[48:49], v[66:67], v[134:135]
v_pk_fma_f32 v[136:137], v[50:51], v[66:67], v[136:137]
v_pk_fma_f32 v[138:139], v[52:53], v[66:67], v[138:139]
v_pk_fma_f32 v[140:141], v[54:55], v[66:67], v[140:141]
v_pk_fma_f32 v[142:143], v[56:57], v[66:67], v[142:143]
v_pk_fma_f32 v[144:145], v[58:59], v[66:67], v[144:145]
v_pk_fma_f32 v[130:131], v[42:43], v[68:69], v[130:131]
v_pk_fma_f32 v[132:133], v[44:45], v[68:69], v[132:133]
v_pk_fma_f32 v[134:135], v[46:47], v[68:69], v[134:135]
v_pk_fma_f32 v[136:137], v[48:49], v[68:69], v[136:137]
v_pk_fma_f32 v[138:139], v[50:51], v[68:69], v[138:139]
v_pk_fma_f32 v[140:141], v[52:53], v[68:69], v[140:141]
v_pk_fma_f32 v[142:143], v[54:55], v[68:69], v[142:143]
v_pk_fma_f32 v[144:145], v[56:57], v[68:69], v[144:145]
v_pk_fma_f32 v[130:131], v[40:41], v[70:71], v[130:131]
v_pk_fma_f32 v[132:133], v[42:43], v[70:71], v[132:133]
v_pk_fma_f32 v[134:135], v[44:45], v[70:71], v[134:135]
v_pk_fma_f32 v[136:137], v[46:47], v[70:71], v[136:137]
v_pk_fma_f32 v[138:139], v[48:49], v[70:71], v[138:139]
v_pk_fma_f32 v[140:141], v[50:51], v[70:71], v[140:141]
v_pk_fma_f32 v[142:143], v[52:53], v[70:71], v[142:143]
v_pk_fma_f32 v[144:145], v[54:55], v[70:71], v[144:145]
v_pk_mul_f32 v[130:131], v[130:131], v[72:73]
v_pk_mul_f32 v[132:133], v[132:133], v[74:75]
v_pk_mul_f32 v[134:135], v[134:135], v[76:77]
v_pk_mul_f32 v[136:137], v[136:137], v[78:79]
v_pk_mul_f32 v[138:139], v[138:139], v[80:81]
v_pk_mul_f32 v[140:141], v[140:141], v[82:83]
v_pk_mul_f32 v[142:143], v[142:143], v[84:85]
v_pk_mul_f32 v[144:145], v[144:145], v[86:87]
v_cvt_pk_bf16_f32 v158, v144, v142
v_cvt_pk_bf16_f32 v162, v145, v143
v_cvt_pk_bf16_f32 v159, v140, v138
v_cvt_pk_bf16_f32 v163, v141, v139
v_cvt_pk_bf16_f32 v160, v136, v134
v_cvt_pk_bf16_f32 v164, v137, v135
v_cvt_pk_bf16_f32 v161, v132, v130
v_cvt_pk_bf16_f32 v165, v133, v131
s_mov_b32 s4, 1310720
s_mov_b32 s5, 1314816
buffer_store_dwordx4 v[158:161], v6, s[52:55], s4 offen sc1
buffer_store_dwordx4 v[162:165], v6, s[52:55], s5 offen sc1
v_lshlrev_b32 v64, 16, v124
v_lshlrev_b32 v65, 16, v126
v_and_b32 v66, 0xffff0000, v124
v_and_b32 v67, 0xffff0000, v126
v_lshlrev_b32 v68, 16, v125
v_lshlrev_b32 v69, 16, v127
v_and_b32 v70, 0xffff0000, v125
v_and_b32 v71, 0xffff0000, v127
s_waitcnt lgkmcnt(0)
v_lshlrev_b32 v40, 16, v16
v_and_b32 v41, s88, v16
v_lshlrev_b32 v42, 16, v17
v_and_b32 v43, s88, v17
v_lshlrev_b32 v44, 16, v18
v_and_b32 v45, s88, v18
v_lshlrev_b32 v46, 16, v19
v_and_b32 v47, s88, v19
v_lshlrev_b32 v48, 16, v20
v_and_b32 v49, s88, v20
v_lshlrev_b32 v50, 16, v21
v_and_b32 v51, s88, v21
v_lshlrev_b32 v52, 16, v22
v_and_b32 v53, s88, v22
v_lshlrev_b32 v54, 16, v23
v_and_b32 v55, s88, v23
v_lshlrev_b32 v56, 16, v24
v_and_b32 v57, s88, v24
v_lshlrev_b32 v58, 16, v25
v_and_b32 v59, s88, v25
v_lshlrev_b32 v60, 16, v26
v_and_b32 v61, s88, v26
v_lshlrev_b32 v72, 16, v27
v_and_b32 v73, s88, v27
v_lshlrev_b32 v74, 16, v28
v_and_b32 v75, s88, v28
v_lshlrev_b32 v76, 16, v29
v_and_b32 v77, s88, v29
v_lshlrev_b32 v78, 16, v30
v_and_b32 v79, s88, v30
v_lshlrev_b32 v80, 16, v31
v_and_b32 v81, s88, v31
v_lshlrev_b32 v82, 16, v32
v_and_b32 v83, s88, v32
v_lshlrev_b32 v84, 16, v33
v_and_b32 v85, s88, v33
v_lshlrev_b32 v86, 16, v34
v_and_b32_e64 v87, s88, v34
v_pk_mul_f32 v[130:131], v[46:47], v[64:65]
v_pk_mul_f32 v[132:133], v[48:49], v[64:65]
v_pk_mul_f32 v[134:135], v[50:51], v[64:65]
v_pk_mul_f32 v[136:137], v[52:53], v[64:65]
v_pk_mul_f32 v[138:139], v[54:55], v[64:65]
v_pk_mul_f32 v[140:141], v[56:57], v[64:65]
v_pk_mul_f32 v[142:143], v[58:59], v[64:65]
v_pk_mul_f32 v[144:145], v[60:61], v[64:65]
v_pk_fma_f32 v[130:131], v[44:45], v[66:67], v[130:131]
v_pk_fma_f32 v[132:133], v[46:47], v[66:67], v[132:133]
v_pk_fma_f32 v[134:135], v[48:49], v[66:67], v[134:135]
v_pk_fma_f32 v[136:137], v[50:51], v[66:67], v[136:137]
v_pk_fma_f32 v[138:139], v[52:53], v[66:67], v[138:139]
v_pk_fma_f32 v[140:141], v[54:55], v[66:67], v[140:141]
v_pk_fma_f32 v[142:143], v[56:57], v[66:67], v[142:143]
v_pk_fma_f32 v[144:145], v[58:59], v[66:67], v[144:145]
v_pk_fma_f32 v[130:131], v[42:43], v[68:69], v[130:131]
v_pk_fma_f32 v[132:133], v[44:45], v[68:69], v[132:133]
v_pk_fma_f32 v[134:135], v[46:47], v[68:69], v[134:135]
v_pk_fma_f32 v[136:137], v[48:49], v[68:69], v[136:137]
v_pk_fma_f32 v[138:139], v[50:51], v[68:69], v[138:139]
v_pk_fma_f32 v[140:141], v[52:53], v[68:69], v[140:141]
v_pk_fma_f32 v[142:143], v[54:55], v[68:69], v[142:143]
v_pk_fma_f32 v[144:145], v[56:57], v[68:69], v[144:145]
v_pk_fma_f32 v[130:131], v[40:41], v[70:71], v[130:131]
v_pk_fma_f32 v[132:133], v[42:43], v[70:71], v[132:133]
v_pk_fma_f32 v[134:135], v[44:45], v[70:71], v[134:135]
v_pk_fma_f32 v[136:137], v[46:47], v[70:71], v[136:137]
v_pk_fma_f32 v[138:139], v[48:49], v[70:71], v[138:139]
v_pk_fma_f32 v[140:141], v[50:51], v[70:71], v[140:141]
v_pk_fma_f32 v[142:143], v[52:53], v[70:71], v[142:143]
v_pk_fma_f32 v[144:145], v[54:55], v[70:71], v[144:145]
v_pk_mul_f32 v[130:131], v[130:131], v[72:73]
v_pk_mul_f32 v[132:133], v[132:133], v[74:75]
v_pk_mul_f32 v[134:135], v[134:135], v[76:77]
v_pk_mul_f32 v[136:137], v[136:137], v[78:79]
v_pk_mul_f32 v[138:139], v[138:139], v[80:81]
v_pk_mul_f32 v[140:141], v[140:141], v[82:83]
v_pk_mul_f32 v[142:143], v[142:143], v[84:85]
v_pk_mul_f32 v[144:145], v[144:145], v[86:87]
v_cvt_pk_bf16_f32 v150, v144, v142
v_cvt_pk_bf16_f32 v154, v145, v143
v_cvt_pk_bf16_f32 v151, v140, v138
v_cvt_pk_bf16_f32 v155, v141, v139
v_cvt_pk_bf16_f32 v152, v136, v134
v_cvt_pk_bf16_f32 v156, v137, v135
v_cvt_pk_bf16_f32 v153, v132, v130
v_cvt_pk_bf16_f32 v157, v133, v131
s_mov_b32 s4, 1572864
s_mov_b32 s5, 1576960
buffer_store_dwordx4 v[150:153], v6, s[52:55], s4 offen sc1
buffer_store_dwordx4 v[154:157], v6, s[52:55], s5 offen sc1
s_waitcnt vmcnt(0) lgkmcnt(0)
s_barrier
s_cmp_lg_u32 s80, 0
s_cbranch_scc1 Lpsig_21
v_mov_b32_e64 v9, 0
s_mov_b32 s5, 0x40000
Lspin_22:
global_load_dword v8, v9, s[38:39] sc1
s_waitcnt vmcnt(0)
v_readfirstlane_b32 s6, v8
s_sub_u32 s5, s5, 1
s_cmp_ge_u32 s6, 1
s_cbranch_scc1 Lspun_23
s_sleep 1
s_cmp_lg_u32 s5, 0
s_cbranch_scc1 Lspin_22
Lspun_23:
Lpsig_21:
v_mov_b32 v9, 11029504
s_cmp_lg_u32 s80, 0
s_cbranch_scc1 Lsig_24
v_mov_b32 v8, 1
s_mov_b64 exec, 1
global_atomic_add v9, v8, s[40:41] sc1
s_mov_b64 exec, -1
Lsig_24:
L_exit:
s_endpgm
L_code_end:
.section .rodata,"a"
.p2align 6
.amdhsa_kernel recurrent_scan__ssm_conv_h3__geglu_ffn__prompt_kernel
  .amdhsa_next_free_vgpr 512
  .amdhsa_next_free_sgpr 102
  .amdhsa_accum_offset 256
  .amdhsa_group_segment_fixed_size 0
  .amdhsa_kernarg_size 104
  .amdhsa_user_sgpr_count 2
  .amdhsa_user_sgpr_kernarg_segment_ptr 1
  .amdhsa_system_sgpr_workgroup_id_x 1
  .amdhsa_float_denorm_mode_32 3
.end_amdhsa_kernel
```
